```python
import torch

def _softmax(x, axis=-1):
    return torch.softmax(x, dim=axis)
def _gelu(x):
    return torch.nn.functional.gelu(x, approximate="tanh")
def _silu(x):
    return torch.nn.functional.silu(x)
def _sigmoid(x):
    return torch.sigmoid(x)
def _layernorm(x, axis=-1, eps=1e-5):
    m = x.mean(dim=axis, keepdim=True)
    v = x.var(dim=axis, keepdim=True, unbiased=False)
    return (x - m) / torch.sqrt(v + eps)
def _scatter_add(tgt, idx, src, axis=0):
    return tgt.clone().index_add_(axis, idx, src)
def _segment_sum(src, seg, n):
    out = torch.zeros((n,) + src.shape[1:], dtype=src.dtype)
    return out.index_add_(0, seg, src)
def _pad(x, pw):
    flat = tuple(v for pair in reversed(pw) for v in pair)
    return torch.nn.functional.pad(x, flat)

kernel_name = 'interleave_layers__linear_attn_block__glu_gated_glu__prompt'

def setup_inputs():

    _w = (lambda a: (lambda t: t.to(torch.bfloat16) if t.is_floating_point() else t)(torch.as_tensor(a)))
    def _A_setup():
        B, S, D = 1, 2048, 640
        return {
            "x": _w((lambda *s: torch.randn(*s, dtype=torch.bfloat16) * 0.05)(B, S, D)),
            "wqkv": _w((lambda *s: torch.randn(*s, dtype=torch.bfloat16) * 0.05)(D, 3 * D)),
            "wo": _w((lambda *s: torch.randn(*s, dtype=torch.bfloat16) * 0.05)(D, D)),
        }
    _A_in = _A_setup()

    def _B_setup():
        B, S, D, F = 1, 2048, 640, 1728
        return {
            "x": _w((lambda *s: torch.randn(*s, dtype=torch.bfloat16) * 0.05)(B, S, D)),
            "w_gate": _w((lambda *s: torch.randn(*s, dtype=torch.bfloat16) * 0.05)(D, F)),
            "w_up": _w((lambda *s: torch.randn(*s, dtype=torch.bfloat16) * 0.05)(D, F)),
            "w_down": _w((lambda *s: torch.randn(*s, dtype=torch.bfloat16) * 0.05)(F, D)),
        }
    _B_in = _B_setup()

    return {
        "A_x": _A_in["x"],
        "A_wqkv": _A_in["wqkv"],
        "A_wo": _A_in["wo"],
        "B_x": _B_in["x"],
        "B_w_gate": _B_in["w_gate"],
        "B_w_up": _B_in["w_up"],
        "B_w_down": _B_in["w_down"],
    }

def reference(A_x, A_wqkv, A_wo, B_x, B_w_gate, B_w_up, B_w_down):
    def _A_ref(x, wqkv, wo):
        B, S, D = x.shape
        H = 32; Dh = D // H
        qkv = (lambda x, *d: x.permute(*d))((x @ wqkv).reshape(B, S, 3, H, Dh), 2, 0, 3, 1, 4)
        q, k, v = qkv[0], qkv[1], qkv[2]
        phi = lambda t: torch.where(t > 0, t + 1, torch.exp(t)) + 1e-6
        pq, pk = phi(q), phi(k)
        kv = torch.einsum("bhsd,bhse->bhde", pk, v)
        z = torch.einsum("bhsd->bhd", pk)
        num = torch.einsum("bhqd,bhde->bhqe", pq, kv)
        den = torch.einsum("bhqd,bhd->bhq", pq, z)[..., None] + 1e-6
        o = num / den
        return (lambda x, *d: x.permute(*d))(o, 0, 2, 1, 3).reshape(B, S, D) @ wo

    def _B_ref(x, w_gate, w_up, w_down):
        g = torch.einsum("bsd,df->bsf", x, w_gate)
        u = torch.einsum("bsd,df->bsf", x, w_up)
        h = _sigmoid(g) * u
        return torch.einsum("bsf,fd->bsd", h, w_down)

    x = A_x
    x = x + _A_ref(_layernorm(x, axis=-1), A_wqkv, A_wo)
    x = x + _B_ref(_layernorm(x, axis=-1), B_w_gate, B_w_up, B_w_down)
    x = x + _A_ref(_layernorm(x, axis=-1), A_wqkv, A_wo)
    x = x + _B_ref(_layernorm(x, axis=-1), B_w_gate, B_w_up, B_w_down)
    return x
```

```asm
; @launch kernel=main_kernel grid=(256,1,1) block=(256,1,1) lds=163840
.amdgcn_target "amdgcn-amd-amdhsa--gfx950"
.text
.globl main_kernel
.p2align 8
.type main_kernel,@function
main_kernel:
s_cmp_ge_u32 s2, 256
s_cbranch_scc1 M_end
s_load_dwordx4 s[20:23], s[0:1], 0
s_load_dwordx4 s[28:31], s[0:1], 32
s_load_dwordx2 s[24:25], s[0:1], 16
s_load_dwordx2 s[26:27], s[0:1], 48
s_load_dwordx2 s[44:45], s[0:1], 64
s_load_dwordx2 s[4:5], s[0:1], 72
v_lshrrev_b32 v1, 6, v0
v_and_b32 v0, 63, v0
v_readfirstlane_b32 s3, v1
v_lshlrev_b32 v1, 4, v0
v_lshrrev_b32 v2, 4, v0
v_and_b32 v3, 15, v0
v_bfe_u32 v4, v0, 2, 2
v_and_b32 v5, 3, v0
v_mov_b32 v8, 0x3f803f80
v_mov_b32 v9, 0x3f803f80
v_mov_b32 v10, 0x3f803f80
v_mov_b32 v11, 0x3f803f80
s_mov_b32 s6, 268435456
s_mov_b32 s7, 0x20000
s_mov_b32 s46, 256
s_mov_b32 s47, 0x20000
v_mov_b32 v66, 0
v_mov_b32 v65, 1073741824
v_cmp_eq_u32 vcc, 0, v0
s_nop 1
v_cndmask_b32 v65, v65, v66, vcc
v_mov_b32 v64, 0
s_mov_b32 s50, 0
s_mov_b32 s92, 0
v_mov_b32 v252, 1073741824
v_mov_b32 v68, 0
v_mov_b32 v69, 0
v_mov_b32 v70, 0
v_mov_b32 v71, 0
s_add_u32 s54, s2, s3
s_cmp_eq_u32 s54, 0
s_cbranch_scc0 L_if1
s_memrealtime s[54:55]
s_waitcnt lgkmcnt(0)
s_or_b32 s54, s54, 1
v_mov_b32 v64, s54
buffer_store_dword v64, v66, s[44:47], 0 offen sc1
L_if1:
s_add_u32 s51, s2, 26
s_mov_b32 s33, 255
s_mov_b32 s32, 53248
s_cmp_ge_u32 s2, 224
s_cbranch_scc0 F_first
s_sub_u32 s51, s2, 224
s_add_u32 s32, s51, 160
s_cmp_lt_u32 s51, 26
s_cselect_b32 s33, s32, 255
s_cselect_b32 s32, 134, -6
s_cmp_lt_u32 s51, 20
s_cselect_b32 s32, 0, s32
s_add_u32 s51, s51, s32
s_mov_b32 s52, s51
s_cmp_lt_u32 s33, 186
s_cselect_b32 s51, s33, s51
s_cselect_b32 s32, 0, 53248
s_branch F_second
F_first:
s_cmp_ge_u32 s2, 128
s_cbranch_scc1 F_Q
s_waitcnt lgkmcnt(0)
s_mov_b32 s8, s20
s_mov_b32 s9, s21
s_mov_b32 s10, 2621440
s_mov_b32 s11, 0x20000
v_lshrrev_b32 v6, 2, v0
v_mul_u32_u24 v6, 1280, v6
v_lshl_add_u32 v6, v5, 4, v6
s_mul_i32 s12, s2, 20480
s_mul_i32 s13, s3, 320
s_add_u32 s13, s13, s12
s_mul_i32 s16, s3, 5120
s_add_u32 m0, s16, 0
s_nop 0
buffer_load_dwordx4 v6, s[8:11], s13 offen offset:0 lds
s_add_u32 m0, s16, 960
s_nop 0
buffer_load_dwordx4 v6, s[8:11], s13 offen offset:64 lds
s_add_u32 m0, s16, 1920
s_nop 0
buffer_load_dwordx4 v6, s[8:11], s13 offen offset:128 lds
s_add_u32 m0, s16, 2880
s_nop 0
buffer_load_dwordx4 v6, s[8:11], s13 offen offset:192 lds
s_add_u32 m0, s16, 3840
s_nop 0
buffer_load_dwordx4 v6, s[8:11], s13 offen offset:256 lds
v_lshlrev_b32 v7, 6, v3
v_lshl_add_u32 v7, v2, 4, v7
v_add_u32 v7, s16, v7
s_waitcnt vmcnt(0)
s_cmp_eq_u32 s3, 0
s_cbranch_scc0 L_if2
buffer_load_dword v64, v66, s[44:47], 0 offen sc1
L_if2:
ds_read_b128 v[16:19], v7 offset:0
ds_read_b128 v[20:23], v7 offset:1024
ds_read_b128 v[24:27], v7 offset:2048
ds_read_b128 v[28:31], v7 offset:3072
ds_read_b128 v[32:35], v7 offset:4096
s_mul_i32 s14, s3, 5120
s_add_u32 s14, s14, s12
s_add_u32 s14, s14, 10616832
s_add_u32 s15, s14, 4096
v_mov_b32 v12, 0
v_mov_b32 v13, 0
s_waitcnt lgkmcnt(4)
buffer_store_dwordx4 v[16:19], v1, s[4:7], s14 offen offset:0 sc1
v_lshlrev_b32 v14, 16, v16
v_and_b32 v15, 0xffff0000, v16
v_add_f32 v12, v12, v14
v_fmac_f32 v13, v14, v14
v_add_f32 v12, v12, v15
v_fmac_f32 v13, v15, v15
v_lshlrev_b32 v14, 16, v17
v_and_b32 v15, 0xffff0000, v17
v_add_f32 v12, v12, v14
v_fmac_f32 v13, v14, v14
v_add_f32 v12, v12, v15
v_fmac_f32 v13, v15, v15
v_lshlrev_b32 v14, 16, v18
v_and_b32 v15, 0xffff0000, v18
v_add_f32 v12, v12, v14
v_fmac_f32 v13, v14, v14
v_add_f32 v12, v12, v15
v_fmac_f32 v13, v15, v15
v_lshlrev_b32 v14, 16, v19
v_and_b32 v15, 0xffff0000, v19
v_add_f32 v12, v12, v14
v_fmac_f32 v13, v14, v14
v_add_f32 v12, v12, v15
v_fmac_f32 v13, v15, v15
s_waitcnt lgkmcnt(3)
buffer_store_dwordx4 v[20:23], v1, s[4:7], s14 offen offset:1024 sc1
v_lshlrev_b32 v14, 16, v20
v_and_b32 v15, 0xffff0000, v20
v_add_f32 v12, v12, v14
v_fmac_f32 v13, v14, v14
v_add_f32 v12, v12, v15
v_fmac_f32 v13, v15, v15
v_lshlrev_b32 v14, 16, v21
v_and_b32 v15, 0xffff0000, v21
v_add_f32 v12, v12, v14
v_fmac_f32 v13, v14, v14
v_add_f32 v12, v12, v15
v_fmac_f32 v13, v15, v15
v_lshlrev_b32 v14, 16, v22
v_and_b32 v15, 0xffff0000, v22
v_add_f32 v12, v12, v14
v_fmac_f32 v13, v14, v14
v_add_f32 v12, v12, v15
v_fmac_f32 v13, v15, v15
v_lshlrev_b32 v14, 16, v23
v_and_b32 v15, 0xffff0000, v23
v_add_f32 v12, v12, v14
v_fmac_f32 v13, v14, v14
v_add_f32 v12, v12, v15
v_fmac_f32 v13, v15, v15
s_waitcnt lgkmcnt(2)
buffer_store_dwordx4 v[24:27], v1, s[4:7], s14 offen offset:2048 sc1
v_lshlrev_b32 v14, 16, v24
v_and_b32 v15, 0xffff0000, v24
v_add_f32 v12, v12, v14
v_fmac_f32 v13, v14, v14
v_add_f32 v12, v12, v15
v_fmac_f32 v13, v15, v15
v_lshlrev_b32 v14, 16, v25
v_and_b32 v15, 0xffff0000, v25
v_add_f32 v12, v12, v14
v_fmac_f32 v13, v14, v14
v_add_f32 v12, v12, v15
v_fmac_f32 v13, v15, v15
v_lshlrev_b32 v14, 16, v26
v_and_b32 v15, 0xffff0000, v26
v_add_f32 v12, v12, v14
v_fmac_f32 v13, v14, v14
v_add_f32 v12, v12, v15
v_fmac_f32 v13, v15, v15
v_lshlrev_b32 v14, 16, v27
v_and_b32 v15, 0xffff0000, v27
v_add_f32 v12, v12, v14
v_fmac_f32 v13, v14, v14
v_add_f32 v12, v12, v15
v_fmac_f32 v13, v15, v15
s_waitcnt lgkmcnt(1)
buffer_store_dwordx4 v[28:31], v1, s[4:7], s14 offen offset:3072 sc1
v_lshlrev_b32 v14, 16, v28
v_and_b32 v15, 0xffff0000, v28
v_add_f32 v12, v12, v14
v_fmac_f32 v13, v14, v14
v_add_f32 v12, v12, v15
v_fmac_f32 v13, v15, v15
v_lshlrev_b32 v14, 16, v29
v_and_b32 v15, 0xffff0000, v29
v_add_f32 v12, v12, v14
v_fmac_f32 v13, v14, v14
v_add_f32 v12, v12, v15
v_fmac_f32 v13, v15, v15
v_lshlrev_b32 v14, 16, v30
v_and_b32 v15, 0xffff0000, v30
v_add_f32 v12, v12, v14
v_fmac_f32 v13, v14, v14
v_add_f32 v12, v12, v15
v_fmac_f32 v13, v15, v15
v_lshlrev_b32 v14, 16, v31
v_and_b32 v15, 0xffff0000, v31
v_add_f32 v12, v12, v14
v_fmac_f32 v13, v14, v14
v_add_f32 v12, v12, v15
v_fmac_f32 v13, v15, v15
s_waitcnt lgkmcnt(0)
buffer_store_dwordx4 v[32:35], v1, s[4:7], s15 offen offset:0 sc1
v_lshlrev_b32 v14, 16, v32
v_and_b32 v15, 0xffff0000, v32
v_add_f32 v12, v12, v14
v_fmac_f32 v13, v14, v14
v_add_f32 v12, v12, v15
v_fmac_f32 v13, v15, v15
v_lshlrev_b32 v14, 16, v33
v_and_b32 v15, 0xffff0000, v33
v_add_f32 v12, v12, v14
v_fmac_f32 v13, v14, v14
v_add_f32 v12, v12, v15
v_fmac_f32 v13, v15, v15
v_lshlrev_b32 v14, 16, v34
v_and_b32 v15, 0xffff0000, v34
v_add_f32 v12, v12, v14
v_fmac_f32 v13, v14, v14
v_add_f32 v12, v12, v15
v_fmac_f32 v13, v15, v15
v_lshlrev_b32 v14, 16, v35
v_and_b32 v15, 0xffff0000, v35
v_add_f32 v12, v12, v14
v_fmac_f32 v13, v14, v14
v_add_f32 v12, v12, v15
v_fmac_f32 v13, v15, v15
v_mov_b32 v14, v12
v_mov_b32 v15, v13
s_nop 0
v_permlane32_swap_b32 v12, v14
v_permlane32_swap_b32 v13, v15
v_add_f32 v12, v12, v14
v_add_f32 v13, v13, v15
v_lshlrev_b32 v6, 3, v0
v_cmp_gt_u32 vcc, 32, v0
v_mov_b32 v7, 1073741824
s_nop 0
v_cndmask_b32 v6, v7, v6, vcc
s_lshl_b32 s12, s2, 10
s_lshl_b32 s13, s3, 8
s_add_u32 s12, s12, s13
s_add_u32 s12, s12, 21102592
buffer_store_dwordx2 v[12:13], v6, s[4:7], s12 offen sc1
s_cmp_eq_u32 s3, 0
s_cbranch_scc0 L_if3
s_lshr_b32 s12, s2, 3
s_lshl_b32 s12, s12, 12
s_and_b32 s13, s2, 7
s_lshl_b32 s14, s13, 9
s_add_u32 s14, s14, s12
s_add_u32 s14, s14, 0
v_lshrrev_b32 v6, 3, v0
v_lshlrev_b32 v6, 8, v6
v_and_b32 v7, 7, v0
v_lshl_add_u32 v6, v7, 4, v6
v_cmp_gt_u32 vcc, 16, v0
v_mov_b32 v7, 1073741824
s_nop 0
v_cndmask_b32 v6, v7, v6, vcc
buffer_store_dwordx4 v[68:71], v6, s[4:7], s14 offen sc1
s_lshr_b32 s12, s12, 4
s_lshl_b32 s13, s13, 2
s_add_u32 s12, s12, s13
s_add_u32 s50, s12, 65536
L_if3:
s_waitcnt vmcnt(0)
s_barrier
s_cmp_eq_u32 s3, 0
s_cbranch_scc0 L_if14
v_readfirstlane_b32 s92, v64
s_mov_b32 s54, 0
F_tkX:
s_cmp_lg_u32 s92, 0
s_cbranch_scc1 F_tkdX
buffer_load_dword v64, v66, s[44:47], 0 offen sc1
s_waitcnt vmcnt(0)
v_readfirstlane_b32 s92, v64
s_add_u32 s54, s54, 1
s_cmp_lt_u32 s54, 100000
s_cbranch_scc1 F_tkX
F_tkdX:
buffer_store_dword v64, v65, s[4:7], s50 offen sc1
L_if14:
F_second:
s_cmp_ge_u32 s51, 186
s_cbranch_scc1 F_join
s_sub_u32 s12, s51, 20
s_cmp_lt_u32 s12, 112
s_cbranch_scc1 F_G
F_D:
s_cmp_lt_u32 s51, 20
s_cselect_b32 s12, 0, 112
s_sub_u32 s12, s51, s12
s_cmp_lt_u32 s51, 20
s_waitcnt lgkmcnt(0)
s_cselect_b32 s8, s24, s26
s_cselect_b32 s9, s25, s27
s_mov_b32 s10, 2211840
s_cmov_b32 s10, 819200
s_mov_b32 s11, 0x20000
s_cselect_b32 s13, 0, 20
s_mov_b32 s35, 8404992
s_cmov_b32 s35, 2883584
s_mov_b32 s36, 276480
s_cmov_b32 s36, 102400
s_cselect_b64 s[42:43], -1, 0
s_sub_u32 s12, s12, s13
s_mul_i32 s14, s3, 320
s_mul_i32 s34, s3, 10240
s_add_u32 s34, s34, s32
s_mov_b32 s19, 52429
s_lshl_b32 s15, s12, 2
s_lshl_b32 s38, s12, 1
s_add_u32 s38, s38, 0
s_lshr_b32 s39, s38, 2
s_mul_i32 s39, s39, 3
s_add_u32 s39, s39, s38
s_sub_u32 s40, s38, 63
s_mul_i32 s41, s40, 171
s_lshr_b32 s41, s41, 9
s_lshl_b32 s41, s41, 2
s_add_u32 s41, s41, s40
s_add_u32 s41, s41, 4
s_cmp_lt_u32 s38, 63
s_cselect_b32 s39, s39, s41
s_sub_u32 s39, s39, 0
s_lshl_b32 s16, s39, 4
s_lshl_b32 s38, s12, 1
s_add_u32 s38, s38, 1
s_lshr_b32 s39, s38, 2
s_mul_i32 s39, s39, 3
s_add_u32 s39, s39, s38
s_sub_u32 s40, s38, 63
s_mul_i32 s41, s40, 171
s_lshr_b32 s41, s41, 9
s_lshl_b32 s41, s41, 2
s_add_u32 s41, s41, s40
s_add_u32 s41, s41, 4
s_cmp_lt_u32 s38, 63
s_cselect_b32 s39, s39, s41
s_sub_u32 s39, s39, 1
s_lshl_b32 s17, s39, 4
s_add_u32 s38, s15, 0
s_mul_i32 s39, s38, s19
s_lshr_b32 s39, s39, 18
s_mul_i32 s39, s39, 5
s_add_u32 s39, s39, s38
s_lshl_b32 s39, s39, 2
s_add_u32 s40, s16, 0
s_cmp_lt_u32 s51, 20
s_cselect_b32 s39, s39, s40
s_mul_i32 s39, s39, 1280
v_mov_b32 v36, s39
s_add_u32 s38, s15, 1
s_mul_i32 s39, s38, s19
s_lshr_b32 s39, s39, 18
s_mul_i32 s39, s39, 5
s_add_u32 s39, s39, s38
s_lshl_b32 s39, s39, 2
s_add_u32 s40, s16, 8
s_cmp_lt_u32 s51, 20
s_cselect_b32 s39, s39, s40
s_mul_i32 s39, s39, 1280
v_mov_b32 v37, s39
s_add_u32 s38, s15, 2
s_mul_i32 s39, s38, s19
s_lshr_b32 s39, s39, 18
s_mul_i32 s39, s39, 5
s_add_u32 s39, s39, s38
s_lshl_b32 s39, s39, 2
s_add_u32 s40, s17, 16
s_cmp_lt_u32 s51, 20
s_cselect_b32 s39, s39, s40
s_mul_i32 s39, s39, 1280
v_mov_b32 v38, s39
s_add_u32 s38, s15, 3
s_mul_i32 s39, s38, s19
s_lshr_b32 s39, s39, 18
s_mul_i32 s39, s39, 5
s_add_u32 s39, s39, s38
s_lshl_b32 s39, s39, 2
s_add_u32 s40, s17, 24
s_cmp_lt_u32 s51, 20
s_cselect_b32 s39, s39, s40
s_mul_i32 s39, s39, 1280
v_mov_b32 v39, s39
s_cselect_b32 s16, 20, 4
s_movk_i32 s17, 1280
v_add_u32 v6, 0, v0
v_mul_u32_u24 v7, s19, v6
v_lshrrev_b32 v7, 20, v7
v_cmp_gt_u32 vcc, 8, v7
v_mul_u32_u24 v12, 20, v7
v_sub_u32 v6, v6, v12
v_bfe_u32 v12, v7, 2, 1
v_and_b32 v13, 3, v7
v_mad_u32_u24 v12, v12, s16, v13
v_mul_u32_u24 v12, s17, v12
v_lshl_add_u32 v6, v6, 4, v12
v_cndmask_b32 v12, v37, v36, vcc
v_cndmask_b32 v13, v39, v38, vcc
v_add_u32 v12, v12, v6
v_add_u32 v13, v13, v6
s_add_u32 m0, s34, 0
s_nop 0
buffer_load_dwordx4 v12, s[8:11], s14 offen lds
s_add_u32 m0, s34, 5120
s_nop 0
buffer_load_dwordx4 v13, s[8:11], s14 offen lds
v_add_u32 v6, 64, v0
v_mul_u32_u24 v7, s19, v6
v_lshrrev_b32 v7, 20, v7
v_cmp_gt_u32 vcc, 8, v7
v_mul_u32_u24 v12, 20, v7
v_sub_u32 v6, v6, v12
v_bfe_u32 v12, v7, 2, 1
v_and_b32 v13, 3, v7
v_mad_u32_u24 v12, v12, s16, v13
v_mul_u32_u24 v12, s17, v12
v_lshl_add_u32 v6, v6, 4, v12
v_cndmask_b32 v12, v37, v36, vcc
v_cndmask_b32 v13, v39, v38, vcc
v_add_u32 v12, v12, v6
v_add_u32 v13, v13, v6
s_add_u32 m0, s34, 1024
s_nop 0
buffer_load_dwordx4 v12, s[8:11], s14 offen lds
s_add_u32 m0, s34, 6144
s_nop 0
buffer_load_dwordx4 v13, s[8:11], s14 offen lds
v_add_u32 v6, 128, v0
v_mul_u32_u24 v7, s19, v6
v_lshrrev_b32 v7, 20, v7
v_cmp_gt_u32 vcc, 8, v7
v_mul_u32_u24 v12, 20, v7
v_sub_u32 v6, v6, v12
v_bfe_u32 v12, v7, 2, 1
v_and_b32 v13, 3, v7
v_mad_u32_u24 v12, v12, s16, v13
v_mul_u32_u24 v12, s17, v12
v_lshl_add_u32 v6, v6, 4, v12
v_cndmask_b32 v12, v37, v36, vcc
v_cndmask_b32 v13, v39, v38, vcc
v_add_u32 v12, v12, v6
v_add_u32 v13, v13, v6
s_add_u32 m0, s34, 2048
s_nop 0
buffer_load_dwordx4 v12, s[8:11], s14 offen lds
s_add_u32 m0, s34, 7168
s_nop 0
buffer_load_dwordx4 v13, s[8:11], s14 offen lds
v_add_u32 v6, 192, v0
v_mul_u32_u24 v7, s19, v6
v_lshrrev_b32 v7, 20, v7
v_cmp_gt_u32 vcc, 8, v7
v_mul_u32_u24 v12, 20, v7
v_sub_u32 v6, v6, v12
v_bfe_u32 v12, v7, 2, 1
v_and_b32 v13, 3, v7
v_mad_u32_u24 v12, v12, s16, v13
v_mul_u32_u24 v12, s17, v12
v_lshl_add_u32 v6, v6, 4, v12
v_cndmask_b32 v12, v37, v36, vcc
v_cndmask_b32 v13, v39, v38, vcc
v_add_u32 v12, v12, v6
v_add_u32 v13, v13, v6
s_add_u32 m0, s34, 3072
s_nop 0
buffer_load_dwordx4 v12, s[8:11], s14 offen lds
s_add_u32 m0, s34, 8192
s_nop 0
buffer_load_dwordx4 v13, s[8:11], s14 offen lds
v_add_u32 v6, 256, v0
v_mul_u32_u24 v7, s19, v6
v_lshrrev_b32 v7, 20, v7
v_cmp_gt_u32 vcc, 8, v7
v_mul_u32_u24 v12, 20, v7
v_sub_u32 v6, v6, v12
v_bfe_u32 v12, v7, 2, 1
v_and_b32 v13, 3, v7
v_mad_u32_u24 v12, v12, s16, v13
v_mul_u32_u24 v12, s17, v12
v_lshl_add_u32 v6, v6, 4, v12
v_cndmask_b32 v12, v37, v36, vcc
v_cndmask_b32 v13, v39, v38, vcc
v_add_u32 v12, v12, v6
v_add_u32 v13, v13, v6
s_add_u32 m0, s34, 4096
s_nop 0
buffer_load_dwordx4 v12, s[8:11], s14 offen lds
s_add_u32 m0, s34, 9216
s_nop 0
buffer_load_dwordx4 v13, s[8:11], s14 offen lds
s_cmp_eq_u32 s32, 0
s_cmov_b32 s51, s52
s_mov_b32 s32, 53248
s_cbranch_scc1 F_D
F_join:
s_cmp_ge_u32 s51, 186
s_cbranch_scc1 F_main
s_sub_u32 s53, s51, 20
s_cmp_lt_u32 s53, 112
s_cbranch_scc1 F_G2
F_D2:
s_cmp_lt_u32 s51, 20
s_cbranch_scc0 L_if11
s_lshl_b32 s38, s12, 2
s_add_u32 s38, s38, 77824
v_add_u32 v252, s38, v65
L_if11:
v_lshl_add_u32 v6, v2, 3, v4
v_mul_u32_u24 v6, 320, v6
v_add_u32 v6, s34, v6
v_lshl_add_u32 v7, v5, 3, v6
v_lshl_add_u32 v6, v5, 4, v6
s_lshl_b32 s13, s3, 1
s_mul_i32 s13, s13, s36
s_add_u32 s35, s35, s13
s_mul_i32 s13, s12, 5120
s_add_u32 s35, s35, s13
s_cmp_eq_u32 s32, 1
s_cbranch_scc1 F_dw
s_waitcnt vmcnt(0)
F_dw:
s_cmp_ge_u32 s2, 224
s_cselect_b32 s55, s3, 1
s_cmp_eq_u32 s55, 0
s_cbranch_scc0 L_if12
buffer_load_dword v64, v66, s[44:47], 0 offen sc1
L_if12:
ds_read_b64_tr_b16 v[16:17], v6 offset:0
ds_read_b64_tr_b16 v[18:19], v6 offset:1280
s_waitcnt lgkmcnt(0)
buffer_store_dwordx4 v[16:19], v1, s[4:7], s35 offen offset:0 sc1
ds_read_b64_tr_b16 v[20:21], v6 offset:8
ds_read_b64_tr_b16 v[22:23], v6 offset:1288
s_waitcnt lgkmcnt(0)
buffer_store_dwordx4 v[20:23], v1, s[4:7], s35 offen offset:1024 sc1
ds_read_b64_tr_b16 v[24:25], v6 offset:64
ds_read_b64_tr_b16 v[26:27], v6 offset:1344
s_waitcnt lgkmcnt(0)
buffer_store_dwordx4 v[24:27], v1, s[4:7], s35 offen offset:2048 sc1
ds_read_b64_tr_b16 v[28:29], v6 offset:72
ds_read_b64_tr_b16 v[30:31], v6 offset:1352
s_waitcnt lgkmcnt(0)
buffer_store_dwordx4 v[28:31], v1, s[4:7], s35 offen offset:3072 sc1
ds_read_b64_tr_b16 v[16:17], v7 offset:128
ds_read_b64_tr_b16 v[18:19], v7 offset:1408
s_add_u32 s37, s35, 4096
s_waitcnt lgkmcnt(0)
buffer_store_dwordx4 v[16:19], v1, s[4:7], s37 offen offset:0 sc1
s_add_u32 s35, s35, s36
ds_read_b64_tr_b16 v[20:21], v6 offset:160
ds_read_b64_tr_b16 v[22:23], v6 offset:1440
s_waitcnt lgkmcnt(0)
buffer_store_dwordx4 v[20:23], v1, s[4:7], s35 offen offset:0 sc1
ds_read_b64_tr_b16 v[24:25], v6 offset:168
ds_read_b64_tr_b16 v[26:27], v6 offset:1448
s_waitcnt lgkmcnt(0)
buffer_store_dwordx4 v[24:27], v1, s[4:7], s35 offen offset:1024 sc1
ds_read_b64_tr_b16 v[28:29], v6 offset:224
ds_read_b64_tr_b16 v[30:31], v6 offset:1504
s_waitcnt lgkmcnt(0)
buffer_store_dwordx4 v[28:31], v1, s[4:7], s35 offen offset:2048 sc1
ds_read_b64_tr_b16 v[16:17], v6 offset:232
ds_read_b64_tr_b16 v[18:19], v6 offset:1512
s_waitcnt lgkmcnt(0)
buffer_store_dwordx4 v[16:19], v1, s[4:7], s35 offen offset:3072 sc1
ds_read_b64_tr_b16 v[20:21], v7 offset:288
ds_read_b64_tr_b16 v[22:23], v7 offset:1568
s_add_u32 s37, s35, 4096
s_waitcnt lgkmcnt(0)
buffer_store_dwordx4 v[20:23], v1, s[4:7], s37 offen offset:0 sc1
s_cmp_ge_u32 s2, 224
s_cselect_b32 s55, s3, 1
s_cmp_eq_u32 s55, 0
s_cbranch_scc0 L_if13
s_waitcnt vmcnt(10)
v_readfirstlane_b32 s92, v64
s_mov_b32 s54, 0
F_tkD:
s_cmp_lg_u32 s92, 0
s_cbranch_scc1 F_tkdD
buffer_load_dword v64, v66, s[44:47], 0 offen sc1
s_waitcnt vmcnt(0)
v_readfirstlane_b32 s92, v64
s_add_u32 s54, s54, 1
s_cmp_lt_u32 s54, 100000
s_cbranch_scc1 F_tkD
F_tkdD:
L_if13:
F_bdone:
s_cmp_lt_u32 s33, 186
s_cbranch_scc0 F_main
s_mov_b32 s51, s33
s_sub_u32 s12, s33, 132
s_mul_i32 s34, s3, 10240
s_mov_b32 s35, 8404992
s_mov_b32 s36, 276480
s_mov_b32 s33, 255
s_mov_b32 s32, 1
s_branch F_D2
F_Q:
s_waitcnt lgkmcnt(0)
s_mov_b32 s8, s22
s_mov_b32 s9, s23
s_mov_b32 s10, 2457600
s_mov_b32 s11, 0x20000
s_sub_u32 s12, s2, 128
s_cmp_ge_u32 s12, 48
s_cselect_b32 s53, 1, 0
s_cselect_b32 s13, 48, 0
s_cselect_b32 s41, 16, 24
s_sub_u32 s12, s12, s13
s_lshr_b32 s13, s12, 4
s_bfe_u32 s14, s12, 0x20002
s_and_b32 s15, s12, 3
s_mul_i32 s16, s13, 1280
s_mul_i32 s17, s14, 320
s_add_u32 s16, s16, s17
s_mul_i32 s41, s41, s3
s_mul_i32 s17, s15, 160
s_mul_i32 s18, s53, 96
s_add_u32 s17, s17, s18
s_add_u32 s17, s17, s41
s_mul_i32 s17, s17, 3840
s_add_u32 s16, s16, s17
s_mul_i32 s18, s41, 320
s_mov_b32 s19, 52429
v_add_u32 v6, 0, v0
v_mul_u32_u24 v7, s19, v6
v_lshrrev_b32 v7, 20, v7
v_mul_u32_u24 v12, 20, v7
v_sub_u32 v6, v6, v12
v_lshlrev_b32 v6, 4, v6
v_mul_u32_u24 v7, 3840, v7
v_add_u32 v6, v6, v7
s_add_u32 m0, s18, 0
s_nop 0
buffer_load_dwordx4 v6, s[8:11], s16 offen lds
v_add_u32 v6, 64, v0
v_mul_u32_u24 v7, s19, v6
v_lshrrev_b32 v7, 20, v7
v_mul_u32_u24 v12, 20, v7
v_sub_u32 v6, v6, v12
v_lshlrev_b32 v6, 4, v6
v_mul_u32_u24 v7, 3840, v7
v_add_u32 v6, v6, v7
s_add_u32 m0, s18, 1024
s_nop 0
buffer_load_dwordx4 v6, s[8:11], s16 offen lds
v_add_u32 v6, 128, v0
v_mul_u32_u24 v7, s19, v6
v_lshrrev_b32 v7, 20, v7
v_mul_u32_u24 v12, 20, v7
v_sub_u32 v6, v6, v12
v_lshlrev_b32 v6, 4, v6
v_mul_u32_u24 v7, 3840, v7
v_add_u32 v6, v6, v7
s_add_u32 m0, s18, 2048
s_nop 0
buffer_load_dwordx4 v6, s[8:11], s16 offen lds
v_add_u32 v6, 192, v0
v_mul_u32_u24 v7, s19, v6
v_lshrrev_b32 v7, 20, v7
v_mul_u32_u24 v12, 20, v7
v_sub_u32 v6, v6, v12
v_lshlrev_b32 v6, 4, v6
v_mul_u32_u24 v7, 3840, v7
v_add_u32 v6, v6, v7
s_add_u32 m0, s18, 3072
s_nop 0
buffer_load_dwordx4 v6, s[8:11], s16 offen lds
v_add_u32 v6, 256, v0
v_mul_u32_u24 v7, s19, v6
v_lshrrev_b32 v7, 20, v7
v_mul_u32_u24 v12, 20, v7
v_sub_u32 v6, v6, v12
v_lshlrev_b32 v6, 4, v6
v_mul_u32_u24 v7, 3840, v7
v_add_u32 v6, v6, v7
s_add_u32 m0, s18, 4096
s_nop 0
buffer_load_dwordx4 v6, s[8:11], s16 offen lds
s_cmp_eq_u32 s53, 0
s_cbranch_scc0 L_if4
v_add_u32 v6, 320, v0
v_mul_u32_u24 v7, s19, v6
v_lshrrev_b32 v7, 20, v7
v_mul_u32_u24 v12, 20, v7
v_sub_u32 v6, v6, v12
v_lshlrev_b32 v6, 4, v6
v_mul_u32_u24 v7, 3840, v7
v_add_u32 v6, v6, v7
s_add_u32 m0, s18, 5120
s_nop 0
buffer_load_dwordx4 v6, s[8:11], s16 offen lds
v_add_u32 v6, 384, v0
v_mul_u32_u24 v7, s19, v6
v_lshrrev_b32 v7, 20, v7
v_mul_u32_u24 v12, 20, v7
v_sub_u32 v6, v6, v12
v_lshlrev_b32 v6, 4, v6
v_mul_u32_u24 v7, 3840, v7
v_add_u32 v6, v6, v7
s_add_u32 m0, s18, 6144
s_nop 0
buffer_load_dwordx4 v6, s[8:11], s16 offen lds
v_add_u32 v6, 448, v0
v_mul_u32_u24 v7, s19, v6
v_lshrrev_b32 v7, 20, v7
v_mul_u32_u24 v12, 20, v7
v_sub_u32 v6, v6, v12
v_lshlrev_b32 v6, 4, v6
v_mul_u32_u24 v7, 3840, v7
v_add_u32 v6, v6, v7
s_add_u32 m0, s18, 7168
s_nop 0
buffer_load_dwordx4 v6, s[8:11], s16 offen lds
L_if4:
s_lshl_b32 s14, s14, 2
s_add_u32 s14, s14, s3
s_mul_i32 s18, s3, 80
v_lshl_add_u32 v6, v2, 3, v4
v_mul_u32_u24 v6, 320, v6
v_add_u32 v6, s18, v6
v_and_b32 v7, 1, v5
v_mul_u32_u24 v7, 40, v7
v_add3_u32 v7, v7, v6, 32
v_lshl_add_u32 v6, v5, 3, v6
s_mul_i32 s34, s14, 163840
s_add_u32 s34, s34, 131072
s_cmp_eq_u32 s13, 0
s_mov_b32 s37, 5120
s_cmov_b32 s37, 3072
s_cselect_b32 s35, 102400, 0
s_cselect_b32 s38, 5, 0
s_add_u32 s34, s34, s35
s_mul_i32 s35, s15, 5
s_mul_i32 s39, s53, 3
s_add_u32 s35, s35, s39
s_mul_i32 s35, s35, s37
s_add_u32 s34, s34, s35
s_add_u32 s36, s34, 2048
s_add_u32 s40, s38, 2
s_cmp_eq_u32 s13, 2
s_cselect_b32 s35, 3072, 0
s_cselect_b32 s39, 3, 0
s_add_u32 s34, s34, s35
s_add_u32 s38, s38, s39
s_add_u32 s35, s34, 1024
s_add_u32 s39, s38, 1
v_lshrrev_b32 v12, 3, v3
v_add_u32 v12, 1, v12
v_cmp_eq_u32 vcc, s13, v12
s_cmp_eq_u32 s13, 0
s_cselect_b64 s[42:43], -1, 0
s_or_b64 vcc, vcc, s[42:43]
v_mov_b32 v13, 1073741824
v_cndmask_b32 v12, v13, v1, vcc
v_cmp_gt_u32 s[48:49], 16, v0
s_nop 1
v_cndmask_b32 v14, v13, v1, s[48:49]
v_cndmask_b32 v15, v13, v12, s[48:49]
s_lshl_b32 s14, s14, 13
s_lshl_b32 s15, s15, 8
s_add_u32 s14, s14, s15
s_lshl_b32 s15, s53, 3
s_add_u32 s14, s14, s15
s_add_u32 s14, s14, 2752512
s_lshl_b32 s38, s38, 10
s_add_u32 s38, s38, s14
s_lshl_b32 s39, s39, 10
s_add_u32 s39, s39, s14
s_lshl_b32 s40, s40, 10
s_add_u32 s40, s40, s14
s_waitcnt vmcnt(0)
s_barrier
s_cmp_eq_u32 s3, 0
s_cbranch_scc0 L_if5
buffer_load_dword v64, v66, s[44:47], 0 offen sc1
L_if5:
ds_read_b64_tr_b16 v[16:17], v6 offset:0
ds_read_b64_tr_b16 v[18:19], v6 offset:1280
ds_read_b64_tr_b16 v[20:21], v6 offset:40
ds_read_b64_tr_b16 v[22:23], v6 offset:1320
ds_read_b64_tr_b16 v[24:25], v7 offset:0
ds_read_b64_tr_b16 v[26:27], v7 offset:1280
s_waitcnt lgkmcnt(4)
buffer_store_dwordx4 v[16:19], v1, s[4:7], s34 offen sc1
v_mfma_f32_16x16x32_bf16 v[40:43], v[8:11], v[16:19], 0
s_waitcnt lgkmcnt(2)
buffer_store_dwordx4 v[20:23], v1, s[4:7], s35 offen sc1
v_mfma_f32_16x16x32_bf16 v[44:47], v[8:11], v[20:23], 0
s_waitcnt lgkmcnt(0)
buffer_store_dwordx4 v[24:27], v12, s[4:7], s36 offen sc1
v_mfma_f32_16x16x32_bf16 v[48:51], v[8:11], v[24:27], 0
s_add_u32 s34, s34, s37
s_add_u32 s35, s35, s37
s_add_u32 s36, s36, s37
ds_read_b64_tr_b16 v[28:29], v6 offset:10240
ds_read_b64_tr_b16 v[30:31], v6 offset:11520
ds_read_b64_tr_b16 v[32:33], v6 offset:10280
ds_read_b64_tr_b16 v[34:35], v6 offset:11560
ds_read_b64_tr_b16 v[36:37], v7 offset:10240
ds_read_b64_tr_b16 v[38:39], v7 offset:11520
s_waitcnt lgkmcnt(4)
buffer_store_dwordx4 v[28:31], v1, s[4:7], s34 offen sc1
v_mfma_f32_16x16x32_bf16 v[40:43], v[8:11], v[28:31], v[40:43]
s_waitcnt lgkmcnt(2)
buffer_store_dwordx4 v[32:35], v1, s[4:7], s35 offen sc1
v_mfma_f32_16x16x32_bf16 v[44:47], v[8:11], v[32:35], v[44:47]
s_waitcnt lgkmcnt(0)
buffer_store_dwordx4 v[36:39], v12, s[4:7], s36 offen sc1
v_mfma_f32_16x16x32_bf16 v[48:51], v[8:11], v[36:39], v[48:51]
s_add_u32 s34, s34, s37
s_add_u32 s35, s35, s37
s_add_u32 s36, s36, s37
s_cmp_eq_u32 s53, 0
s_cbranch_scc0 L_if6
ds_read_b64_tr_b16 v[16:17], v6 offset:20480
ds_read_b64_tr_b16 v[18:19], v6 offset:21760
ds_read_b64_tr_b16 v[20:21], v6 offset:20520
ds_read_b64_tr_b16 v[22:23], v6 offset:21800
ds_read_b64_tr_b16 v[24:25], v7 offset:20480
ds_read_b64_tr_b16 v[26:27], v7 offset:21760
s_waitcnt lgkmcnt(4)
buffer_store_dwordx4 v[16:19], v1, s[4:7], s34 offen sc1
v_mfma_f32_16x16x32_bf16 v[40:43], v[8:11], v[16:19], v[40:43]
s_waitcnt lgkmcnt(2)
buffer_store_dwordx4 v[20:23], v1, s[4:7], s35 offen sc1
v_mfma_f32_16x16x32_bf16 v[44:47], v[8:11], v[20:23], v[44:47]
s_waitcnt lgkmcnt(0)
buffer_store_dwordx4 v[24:27], v12, s[4:7], s36 offen sc1
v_mfma_f32_16x16x32_bf16 v[48:51], v[8:11], v[24:27], v[48:51]
L_if6:
s_nop 3
v_cvt_pk_bf16_f32 v53, v40, 0
v_lshlrev_b32 v41, 16, v53
v_sub_f32 v41, v40, v41
v_cvt_pk_bf16_f32 v52, v40, v41
buffer_store_dwordx2 v[52:53], v14, s[4:7], s38 offen sc1
v_cvt_pk_bf16_f32 v57, v44, 0
v_lshlrev_b32 v45, 16, v57
v_sub_f32 v45, v44, v45
v_cvt_pk_bf16_f32 v56, v44, v45
buffer_store_dwordx2 v[56:57], v14, s[4:7], s39 offen sc1
v_cvt_pk_bf16_f32 v61, v48, 0
v_lshlrev_b32 v49, 16, v61
v_sub_f32 v49, v48, v49
v_cvt_pk_bf16_f32 v60, v48, v49
buffer_store_dwordx2 v[60:61], v15, s[4:7], s40 offen sc1
s_add_u32 s14, s13, s53
s_lshl_b32 s14, s14, 1
s_add_u32 s14, s14, s3
s_cmp_lt_u32 s14, 2
s_cbranch_scc0 L_if7
s_bfe_u32 s14, s12, 0x20002
s_lshl_b32 s14, s14, 10
s_and_b32 s15, s12, 3
s_lshl_b32 s15, s15, 1
s_add_u32 s15, s15, s3
s_lshl_b32 s15, s15, 13
s_add_u32 s14, s14, s15
s_add_u32 s14, s14, 128
v_lshrrev_b32 v6, 5, v0
v_lshlrev_b32 v6, 12, v6
v_bfe_u32 v7, v0, 3, 2
v_lshl_add_u32 v6, v7, 8, v6
v_and_b32 v7, 7, v0
v_lshl_add_u32 v6, v7, 4, v6
v_mov_b32 v16, 0
v_mov_b32 v17, 0
v_mov_b32 v18, 0
v_mov_b32 v19, 0
buffer_store_dwordx4 v[16:19], v6, s[4:7], s14 offen sc1
L_if7:
s_bfe_u32 s14, s12, 0x20002
s_lshl_b32 s14, s14, 8
s_lshl_b32 s15, s13, 2
s_and_b32 s16, s12, 3
s_add_u32 s15, s15, s16
s_mul_i32 s16, s53, 12
s_add_u32 s15, s15, s16
s_lshl_b32 s15, s15, 2
s_add_u32 s14, s14, s15
s_add_u32 s50, s14, 69632
s_mov_b32 s51, 255
s_waitcnt vmcnt(0)
s_barrier
s_cmp_eq_u32 s3, 0
s_cbranch_scc0 L_if8
v_readfirstlane_b32 s92, v64
s_mov_b32 s54, 0
F_tkQ:
s_cmp_lg_u32 s92, 0
s_cbranch_scc1 F_tkdQ
buffer_load_dword v64, v66, s[44:47], 0 offen sc1
s_waitcnt vmcnt(0)
v_readfirstlane_b32 s92, v64
s_add_u32 s54, s54, 1
s_cmp_lt_u32 s54, 100000
s_cbranch_scc1 F_tkQ
F_tkdQ:
buffer_store_dword v64, v65, s[4:7], s50 offen sc1
L_if8:
s_branch F_second
F_G:
s_sub_u32 s12, s51, 20
s_lshr_b32 s13, s12, 2
s_and_b32 s12, s12, 3
s_mov_b32 s52, s13
s_waitcnt lgkmcnt(0)
s_mov_b32 s8, s28
s_mov_b32 s9, s29
s_mov_b32 s10, 2211840
s_mov_b32 s11, 0x20000
s_mov_b32 s16, s30
s_mov_b32 s17, s31
s_mov_b32 s18, 2211840
s_mov_b32 s19, 0x20000
s_min_u32 s14, s13, 26
s_lshl_b32 s14, s14, 7
s_lshl_b32 s15, s12, 2
s_add_u32 s15, s15, s3
s_mul_i32 s15, s15, 138240
s_add_u32 s14, s14, s15
s_mul_i32 s34, s3, 5120
s_add_u32 s34, s34, 53248
v_lshrrev_b32 v6, 3, v0
v_and_b32 v7, 3, v6
v_lshlrev_b32 v7, 1, v7
v_and_b32 v12, 7, v0
v_xor_b32 v7, v7, v12
v_mul_u32_u24 v6, 3456, v6
v_lshl_add_u32 v6, v7, 4, v6
s_add_u32 m0, s34, 0
s_nop 0
buffer_load_dwordx4 v6, s[8:11], s14 offen lds
s_add_u32 m0, s34, 20480
s_nop 0
buffer_load_dwordx4 v6, s[16:19], s14 offen lds
s_add_u32 s14, s14, 27648
s_add_u32 m0, s34, 1024
s_nop 0
buffer_load_dwordx4 v6, s[8:11], s14 offen lds
s_add_u32 m0, s34, 21504
s_nop 0
buffer_load_dwordx4 v6, s[16:19], s14 offen lds
s_add_u32 s14, s14, 27648
s_add_u32 m0, s34, 2048
s_nop 0
buffer_load_dwordx4 v6, s[8:11], s14 offen lds
s_add_u32 m0, s34, 22528
s_nop 0
buffer_load_dwordx4 v6, s[16:19], s14 offen lds
s_add_u32 s14, s14, 27648
s_add_u32 m0, s34, 3072
s_nop 0
buffer_load_dwordx4 v6, s[8:11], s14 offen lds
s_add_u32 m0, s34, 23552
s_nop 0
buffer_load_dwordx4 v6, s[16:19], s14 offen lds
s_add_u32 s14, s14, 27648
s_add_u32 m0, s34, 4096
s_nop 0
buffer_load_dwordx4 v6, s[8:11], s14 offen lds
s_add_u32 m0, s34, 24576
s_nop 0
buffer_load_dwordx4 v6, s[16:19], s14 offen lds
s_branch F_join
F_G2:
s_lshl_b32 s13, s13, 2
s_add_u32 s13, s13, s3
v_and_b32 v6, 1, v2
v_mul_u32_u24 v6, 20480, v6
v_lshrrev_b32 v7, 5, v0
v_lshl_add_u32 v6, v7, 10, v6
v_lshl_add_u32 v6, v4, 7, v6
v_xor_b32 v7, s3, v4
v_lshl_add_u32 v6, v7, 5, v6
v_and_b32 v7, 1, v5
v_lshl_add_u32 v6, v7, 4, v6
v_lshrrev_b32 v7, 1, v5
v_lshl_add_u32 v6, v7, 3, v6
v_add_u32 v6, 53248, v6
s_mul_i32 s36, s13, 9363
s_lshr_b32 s36, s36, 16
s_mul_i32 s37, s36, 7
s_sub_u32 s37, s13, s37
s_mul_i32 s35, s36, 286720
s_cmp_lt_u32 s37, 4
s_mov_b32 s38, 40960
s_cmov_b32 s38, 1024
s_mov_b32 s39, 1024
s_cmov_b32 s39, 4096
s_mul_i32 s38, s38, s37
s_add_u32 s35, s35, s38
s_mul_i32 s38, s39, 10
s_mul_i32 s38, s38, s12
s_add_u32 s35, s35, s38
s_add_u32 s35, s35, 3702784
v_cmp_gt_u32 vcc, 32, v0
v_mov_b32 v13, 1073741824
s_nop 0
v_cndmask_b32 v12, v13, v1, vcc
s_lshl_b32 s42, s52, 2
s_mul_i32 s43, s42, 9363
s_lshr_b32 s43, s43, 16
s_add_u32 s42, s42, 3
s_mul_i32 s42, s42, 9363
s_lshr_b32 s42, s42, 16
s_cmp_eq_u32 s42, s43
s_cselect_b32 s53, 1, 2
v_mov_b32 v14, s43
v_mov_b32 v15, s42
v_cmp_gt_u32 vcc, 1, v0
s_nop 1
v_cndmask_b32 v14, v15, v14, vcc
v_mul_u32_u24 v15, 7, v14
v_lshrrev_b32 v15, 2, v15
v_sub_u32 v15, s52, v15
v_lshl_add_u32 v15, v15, 2, s12
v_lshlrev_b32 v15, 2, v15
v_lshl_add_u32 v15, v14, 8, v15
v_add_u32 v15, 73728, v15
v_cmp_gt_u32 vcc, s53, v0
s_nop 1
v_cndmask_b32 v252, v13, v15, vcc
s_lshr_b32 s40, s12, 1
s_lshl_b32 s40, s40, 9
s_and_b32 s41, s12, 1
s_lshl_b32 s41, s41, 3
s_add_u32 s40, s40, s41
s_lshl_b32 s41, s13, 10
s_add_u32 s40, s40, s41
s_add_u32 s40, s40, 8290304
s_waitcnt vmcnt(0)
s_barrier
s_cmp_ge_u32 s2, 224
s_cselect_b32 s55, s3, 1
s_cmp_eq_u32 s55, 0
s_cbranch_scc0 L_if9
buffer_load_dword v64, v66, s[44:47], 0 offen sc1
L_if9:
s_cmp_ge_u32 s13, 109
s_cbranch_scc1 F_main
ds_read_b64_tr_b16 v[16:17], v6 offset:0
ds_read_b64_tr_b16 v[18:19], v6 offset:512
s_waitcnt lgkmcnt(0)
buffer_store_dwordx4 v[16:19], v1, s[4:7], s35 offen sc1
s_add_u32 s35, s35, s39
v_mfma_f32_32x32x16_bf16 v[32:47], v[8:11], v[16:19], 0
ds_read_b64_tr_b16 v[20:21], v6 offset:2048
ds_read_b64_tr_b16 v[22:23], v6 offset:2560
s_waitcnt lgkmcnt(0)
buffer_store_dwordx4 v[20:23], v1, s[4:7], s35 offen sc1
s_add_u32 s35, s35, s39
v_mfma_f32_32x32x16_bf16 v[32:47], v[8:11], v[20:23], v[32:47]
ds_read_b64_tr_b16 v[24:25], v6 offset:4096
ds_read_b64_tr_b16 v[26:27], v6 offset:4608
s_waitcnt lgkmcnt(0)
buffer_store_dwordx4 v[24:27], v1, s[4:7], s35 offen sc1
s_add_u32 s35, s35, s39
v_mfma_f32_32x32x16_bf16 v[32:47], v[8:11], v[24:27], v[32:47]
ds_read_b64_tr_b16 v[28:29], v6 offset:6144
ds_read_b64_tr_b16 v[30:31], v6 offset:6656
s_waitcnt lgkmcnt(0)
buffer_store_dwordx4 v[28:31], v1, s[4:7], s35 offen sc1
s_add_u32 s35, s35, s39
v_mfma_f32_32x32x16_bf16 v[32:47], v[8:11], v[28:31], v[32:47]
ds_read_b64_tr_b16 v[16:17], v6 offset:8192
ds_read_b64_tr_b16 v[18:19], v6 offset:8704
s_waitcnt lgkmcnt(0)
buffer_store_dwordx4 v[16:19], v1, s[4:7], s35 offen sc1
s_add_u32 s35, s35, s39
v_mfma_f32_32x32x16_bf16 v[32:47], v[8:11], v[16:19], v[32:47]
ds_read_b64_tr_b16 v[20:21], v6 offset:10240
ds_read_b64_tr_b16 v[22:23], v6 offset:10752
s_waitcnt lgkmcnt(0)
buffer_store_dwordx4 v[20:23], v1, s[4:7], s35 offen sc1
s_add_u32 s35, s35, s39
v_mfma_f32_32x32x16_bf16 v[32:47], v[8:11], v[20:23], v[32:47]
ds_read_b64_tr_b16 v[24:25], v6 offset:12288
ds_read_b64_tr_b16 v[26:27], v6 offset:12800
s_waitcnt lgkmcnt(0)
buffer_store_dwordx4 v[24:27], v1, s[4:7], s35 offen sc1
s_add_u32 s35, s35, s39
v_mfma_f32_32x32x16_bf16 v[32:47], v[8:11], v[24:27], v[32:47]
ds_read_b64_tr_b16 v[28:29], v6 offset:14336
ds_read_b64_tr_b16 v[30:31], v6 offset:14848
s_waitcnt lgkmcnt(0)
buffer_store_dwordx4 v[28:31], v1, s[4:7], s35 offen sc1
s_add_u32 s35, s35, s39
v_mfma_f32_32x32x16_bf16 v[32:47], v[8:11], v[28:31], v[32:47]
ds_read_b64_tr_b16 v[16:17], v6 offset:16384
ds_read_b64_tr_b16 v[18:19], v6 offset:16896
s_waitcnt lgkmcnt(0)
buffer_store_dwordx4 v[16:19], v1, s[4:7], s35 offen sc1
s_add_u32 s35, s35, s39
v_mfma_f32_32x32x16_bf16 v[32:47], v[8:11], v[16:19], v[32:47]
ds_read_b64_tr_b16 v[20:21], v6 offset:18432
ds_read_b64_tr_b16 v[22:23], v6 offset:18944
s_waitcnt lgkmcnt(0)
buffer_store_dwordx4 v[20:23], v1, s[4:7], s35 offen sc1
s_add_u32 s35, s35, s39
v_mfma_f32_32x32x16_bf16 v[32:47], v[8:11], v[20:23], v[32:47]
s_nop 11
v_cvt_pk_bf16_f32 v49, v32, 0
v_lshlrev_b32 v33, 16, v49
v_sub_f32 v33, v32, v33
v_cvt_pk_bf16_f32 v48, v32, v33
buffer_store_dwordx2 v[48:49], v12, s[4:7], s40 offen sc1
s_cmp_ge_u32 s2, 224
s_cselect_b32 s55, s3, 1
s_cmp_eq_u32 s55, 0
s_cbranch_scc0 L_if10
s_waitcnt vmcnt(11)
v_readfirstlane_b32 s92, v64
s_mov_b32 s54, 0
F_tkG:
s_cmp_lg_u32 s92, 0
s_cbranch_scc1 F_tkdG
buffer_load_dword v64, v66, s[44:47], 0 offen sc1
s_waitcnt vmcnt(0)
v_readfirstlane_b32 s92, v64
s_add_u32 s54, s54, 1
s_cmp_lt_u32 s54, 100000
s_cbranch_scc1 F_tkG
F_tkdG:
L_if10:
s_branch F_bdone
F_main:
s_nop 4
s_load_dwordx2 s[8:9], s[0:1], 56
s_mov_b32 s16, s3
s_mov_b32 s6, 268435456
s_mov_b32 s7, 0x20000
s_mov_b32 s10, 2621440
s_mov_b32 s11, 0x20000
s_bfe_u32 s17, s2, 0x20001
s_lshl_b32 s17, s17, 2
s_bfe_u32 s22, s2, 0x20003
s_add_u32 s17, s17, s22
s_and_b32 s20, s2, 1
s_lshr_b32 s21, s2, 5
s_lshl_b32 s18, s20, 3
s_add_u32 s18, s18, s21
v_lshlrev_b32 v1, 4, v0
v_add_u32 v2, 0x10000, v1
v_add_u32 v3, 0x20000, v1
s_mul_i32 s24, s16, 15360
s_mul_i32 s25, s18, 163840
s_add_u32 s25, s25, s24
s_lshl_b32 s22, s17, 8
s_lshr_b32 s23, s18, 2
s_lshl_b32 s23, s23, 8
s_add_u32 s23, s23, 4064
v_mov_b32 v254, s23
v_mov_b32 v23, s22
v_cmp_gt_u32 vcc, 8, v0
s_nop 1
v_cndmask_b32 v254, v254, v23, vcc
v_and_b32 v23, 31, v0
v_lshl_add_u32 v254, v23, 2, v254
s_mov_b32 s101, 65536
s_cmp_eq_u32 s16, 0
s_cbranch_scc0 L_if15
buffer_load_dword v23, v254, s[4:7], s101 offen sc1
L_if15:
s_lshl_b32 s22, s17, 3
s_lshl_b32 s23, s16, 1
s_add_u32 s31, s22, s23
s_lshl_b32 s23, s20, 2
s_add_u32 s22, s22, s23
s_add_u32 s32, s22, s16
s_mov_b32 s19, 0
s_mov_b32 s28, 0
s_mov_b32 s29, 0
s_mov_b32 s30, 0
v_lshrrev_b32 v24, 4, v0
v_and_b32 v25, 15, v0
v_and_b32 v26, 1, v24
v_lshrrev_b32 v27, 5, v0
v_lshlrev_b32 v28, 4, v25
v_lshl_add_u32 v29, v27, 8, v28
v_mul_u32_u24 v30, 20480, v26
v_add_u32 v14, v30, v29
v_mul_u32_u24 v30, 57344, v26
v_add_u32 v15, v30, v29
v_lshlrev_b32 v30, 3, v25
v_lshl_add_u32 v16, v27, 9, v30
v_lshl_add_u32 v16, v26, 10, v16
v_lshl_add_u32 v17, v26, 3, v29
v_mov_b32 v31, 1073741824
v_cmp_eq_u32 s[40:41], 0, v24
v_cmp_eq_u32 s[42:43], 1, v24
v_cmp_gt_u32 s[44:45], 8, v25
v_cmp_le_u32 s[54:55], 2, v24
v_bfe_u32 v30, v0, 2, 1
v_cmp_eq_u32 s[46:47], 1, v30
v_cmp_eq_u32 s[52:53], 0, v30
v_cmp_eq_u32 s[48:49], 2, v24
v_cmp_eq_u32 s[50:51], 3, v24
s_and_b64 s[48:49], s[48:49], s[52:53]
s_and_b64 s[50:51], s[50:51], s[46:47]
v_lshl_add_u32 v30, v26, 3, v28
v_cndmask_b32 v18, v31, v30, s[54:55]
v_cndmask_b32 v19, v31, v28, s[40:41]
v_lshlrev_b32 v20, 4, v24
v_mov_b32 v21, 1
v_cmp_eq_u32 vcc, 0, v0
s_nop 1
v_cndmask_b32 v22, v31, 0, vcc
s_cmp_eq_u32 s16, 0
s_cbranch_scc0 L_if16
s_mov_b32 s22, -1
s_waitcnt vmcnt(0)
v_cmp_eq_u32 vcc, s92, v23
s_mov_b32 s33, 0
L_slot0:
s_and_b32 s23, vcc_lo, s22
s_cmp_eq_u32 s23, s22
s_cbranch_scc1 L_slotd0
buffer_load_dword v23, v254, s[4:7], s101 offen sc1
s_waitcnt vmcnt(0)
v_cmp_eq_u32 vcc, s92, v23
s_add_u32 s33, s33, 1
s_cmp_lt_u32 s33, 100000
s_cbranch_scc1 L_slot0
L_slotd0:
L_if16:
s_barrier
s_add_u32 s26, s25, 131072
s_add_u32 m0, s24, 0
s_nop 0
buffer_load_dwordx4 v1, s[4:7], s26 offen offset:0 lds
buffer_load_dwordx4 v1, s[4:7], s26 offen offset:1024 lds
buffer_load_dwordx4 v1, s[4:7], s26 offen offset:2048 lds
buffer_load_dwordx4 v1, s[4:7], s26 offen offset:3072 lds
s_add_u32 s26, s25, 135168
s_add_u32 m0, s24, 4096
s_nop 0
buffer_load_dwordx4 v1, s[4:7], s26 offen offset:0 lds
buffer_load_dwordx4 v1, s[4:7], s26 offen offset:1024 lds
buffer_load_dwordx4 v1, s[4:7], s26 offen offset:2048 lds
buffer_load_dwordx4 v1, s[4:7], s26 offen offset:3072 lds
s_add_u32 s26, s25, 139264
s_add_u32 m0, s24, 8192
s_nop 0
buffer_load_dwordx4 v1, s[4:7], s26 offen offset:0 lds
buffer_load_dwordx4 v1, s[4:7], s26 offen offset:1024 lds
buffer_load_dwordx4 v1, s[4:7], s26 offen offset:2048 lds
buffer_load_dwordx4 v1, s[4:7], s26 offen offset:3072 lds
s_add_u32 s26, s25, 143360
s_add_u32 m0, s24, 12288
s_nop 0
buffer_load_dwordx4 v1, s[4:7], s26 offen offset:0 lds
buffer_load_dwordx4 v1, s[4:7], s26 offen offset:1024 lds
buffer_load_dwordx4 v1, s[4:7], s26 offen offset:2048 lds
s_lshl_b32 s22, s18, 8
s_add_u32 s22, s22, 8192
s_mov_b32 s23, 12240
v_mov_b32 v254, s23
v_mov_b32 v23, s22
v_cmp_gt_u32 vcc, 12, v0
s_nop 1
v_cndmask_b32 v254, v254, v23, vcc
v_and_b32 v23, 31, v0
v_lshl_add_u32 v254, v23, 2, v254
s_mov_b32 s101, 65536
s_mul_i32 s22, s18, 7
s_add_u32 s23, s22, 6
s_lshr_b32 s22, s22, 2
s_lshr_b32 s23, s23, 2
s_sub_u32 s22, s23, s22
s_cmp_eq_u32 s22, 1
s_cselect_b32 s94, 0xfffff0ff, -1
M_layer:
s_lshl_b32 s98, s31, 10
s_add_u32 s98, s98, s29
s_mul_i32 s99, s31, 20480
s_add_u32 s99, s99, s28
s_lshl_b32 s100, s18, 13
s_mul_i32 s35, s16, 15360
s_mul_i32 s34, s18, 163840
s_add_u32 s34, s34, s35
v_and_b32 v245, 15, v0
v_lshlrev_b32 v245, 3, v245
v_lshl_add_u32 v245, v20, 4, v245
s_add_u32 s98, s98, 21102592
s_cmp_eq_u32 s19, 0
s_cbranch_scc1 L_if19
s_cmp_eq_u32 s16, 0
s_cbranch_scc0 L_if17
s_lshl_b32 s101, s17, 4
s_add_u32 s101, s101, s18
s_lshl_b32 s101, s101, 8
s_add_u32 s101, s101, s30
s_sub_u32 s101, s101, 32
v_mov_b32 v23, 0
buffer_atomic_add v23, v22, s[4:7], s101 offen offset:16 sc0 sc1
L_if17:
s_cmp_eq_u32 s16, 0
s_cbranch_scc0 L_if18
s_waitcnt vmcnt(0)
v_readfirstlane_b32 s23, v23
s_mov_b32 s33, 0
s_cmp_ge_u32 s23, 16
s_cbranch_scc1 L_polld1
L_poll1:
v_mov_b32 v23, 0
buffer_atomic_add v23, v22, s[4:7], s101 offen offset:16 sc0 sc1
s_waitcnt vmcnt(0)
v_readfirstlane_b32 s23, v23
s_add_u32 s33, s33, 1
s_cmp_ge_u32 s23, 16
s_cbranch_scc1 L_polld1
s_cmp_lt_u32 s33, 400000
s_cbranch_scc1 L_poll1
L_polld1:
L_if18:
s_barrier
L_if19:
s_mul_i32 s37, s16, 5120
s_mul_i32 s36, s18, 163840
s_add_u32 s36, s36, s37
s_add_u32 s38, s99, 10616832
buffer_load_dwordx4 a[0:3], v1, s[4:7], s38 offen offset:0 sc1
s_add_u32 s39, s99, 10637312
buffer_load_dwordx4 a[80:83], v1, s[4:7], s39 offen offset:0 sc1
buffer_load_dwordx4 a[4:7], v1, s[4:7], s38 offen offset:1024 sc1
buffer_load_dwordx4 a[84:87], v1, s[4:7], s39 offen offset:1024 sc1
buffer_load_dwordx4 a[8:11], v1, s[4:7], s38 offen offset:2048 sc1
buffer_load_dwordx4 a[88:91], v1, s[4:7], s39 offen offset:2048 sc1
buffer_load_dwordx4 a[12:15], v1, s[4:7], s38 offen offset:3072 sc1
buffer_load_dwordx4 a[92:95], v1, s[4:7], s39 offen offset:3072 sc1
s_add_u32 s38, s99, 10620928
buffer_load_dwordx4 a[16:19], v1, s[4:7], s38 offen offset:0 sc1
s_add_u32 s39, s99, 10641408
buffer_load_dwordx4 a[96:99], v1, s[4:7], s39 offen offset:0 sc1
buffer_load_dwordx4 a[20:23], v1, s[4:7], s38 offen offset:1024 sc1
buffer_load_dwordx4 a[100:103], v1, s[4:7], s39 offen offset:1024 sc1
s_waitcnt vmcnt(12)
s_barrier
s_or_b32 s23, s16, s19
s_cmp_eq_u32 s23, 0
s_cbranch_scc0 L_if20
v_mov_b32 v23, s92
buffer_store_dword v23, v252, s[4:7], 0 offen sc1
L_if20:
buffer_load_dwordx2 v[24:25], v245, s[4:7], s98 offen offset:0 sc1
buffer_load_dwordx2 v[26:27], v245, s[4:7], s98 offen offset:128 sc1
buffer_load_dwordx2 v[28:29], v245, s[4:7], s98 offen offset:1024 sc1
buffer_load_dwordx2 v[30:31], v245, s[4:7], s98 offen offset:1152 sc1
ds_read_b128 v[60:63], v1 offset:0
ds_read_b128 v[64:67], v1 offset:1024
ds_read_b128 v[68:71], v1 offset:2048
ds_read_b128 v[72:75], v1 offset:3072
ds_read_b128 v[76:79], v1 offset:4096
ds_read_b128 v[80:83], v1 offset:5120
ds_read_b128 v[84:87], v1 offset:6144
ds_read_b128 v[88:91], v1 offset:7168
s_waitcnt vmcnt(14) lgkmcnt(0)
v_mfma_f32_16x16x32_bf16 v[100:103], a[0:3], v[60:63], 0
ds_read_b128 v[92:95], v1 offset:8192
v_mfma_f32_16x16x32_bf16 v[104:107], a[80:83], v[60:63], 0
v_mfma_f32_16x16x32_bf16 v[108:111], a[0:3], v[64:67], 0
ds_read_b128 v[96:99], v1 offset:9216
v_mfma_f32_16x16x32_bf16 v[112:115], a[80:83], v[64:67], 0
buffer_load_dwordx4 a[24:27], v1, s[4:7], s38 offen offset:2048 sc1
v_mfma_f32_16x16x32_bf16 v[116:119], a[0:3], v[68:71], 0
ds_read_b128 v[60:63], v1 offset:10240
v_mfma_f32_16x16x32_bf16 v[120:123], a[80:83], v[68:71], 0
v_mfma_f32_16x16x32_bf16 v[124:127], a[0:3], v[72:75], 0
ds_read_b128 v[64:67], v1 offset:11264
v_mfma_f32_16x16x32_bf16 v[128:131], a[80:83], v[72:75], 0
buffer_load_dwordx4 a[104:107], v1, s[4:7], s39 offen offset:2048 sc1
v_mfma_f32_16x16x32_bf16 v[132:135], a[0:3], v[76:79], 0
ds_read_b128 v[68:71], v1 offset:12288
v_mfma_f32_16x16x32_bf16 v[136:139], a[80:83], v[76:79], 0
s_waitcnt vmcnt(14)
v_mfma_f32_16x16x32_bf16 v[100:103], a[4:7], v[80:83], v[100:103]
ds_read_b128 v[72:75], v1 offset:13312
buffer_load_dwordx4 a[28:31], v1, s[4:7], s38 offen offset:3072 sc1
v_mfma_f32_16x16x32_bf16 v[104:107], a[84:87], v[80:83], v[104:107]
v_mfma_f32_16x16x32_bf16 v[108:111], a[4:7], v[84:87], v[108:111]
ds_read_b128 v[76:79], v1 offset:14336
v_mfma_f32_16x16x32_bf16 v[112:115], a[84:87], v[84:87], v[112:115]
v_mfma_f32_16x16x32_bf16 v[116:119], a[4:7], v[88:91], v[116:119]
ds_read_b128 v[80:83], v1 offset:15360
buffer_load_dwordx4 a[108:111], v1, s[4:7], s39 offen offset:3072 sc1
v_mfma_f32_16x16x32_bf16 v[120:123], a[84:87], v[88:91], v[120:123]
s_waitcnt lgkmcnt(6)
v_mfma_f32_16x16x32_bf16 v[124:127], a[4:7], v[92:95], v[124:127]
ds_read_b128 v[84:87], v1 offset:16384
v_mfma_f32_16x16x32_bf16 v[128:131], a[84:87], v[92:95], v[128:131]
s_add_u32 s96, s36, 192512
s_add_u32 m0, s37, 61440
s_nop 0
buffer_load_dwordx4 v1, s[4:7], s96 offen offset:0 lds
v_mfma_f32_16x16x32_bf16 v[132:135], a[4:7], v[96:99], v[132:135]
ds_read_b128 v[88:91], v1 offset:17408
v_mfma_f32_16x16x32_bf16 v[136:139], a[84:87], v[96:99], v[136:139]
s_waitcnt vmcnt(15) lgkmcnt(6)
v_mfma_f32_16x16x32_bf16 v[100:103], a[8:11], v[60:63], v[100:103]
ds_read_b128 v[92:95], v1 offset:18432
v_mfma_f32_16x16x32_bf16 v[104:107], a[88:91], v[60:63], v[104:107]
buffer_load_dwordx4 v1, s[4:7], s96 offen offset:1024 lds
v_mfma_f32_16x16x32_bf16 v[108:111], a[8:11], v[64:67], v[108:111]
ds_read_b128 v[96:99], v1 offset:19456
v_mfma_f32_16x16x32_bf16 v[112:115], a[88:91], v[64:67], v[112:115]
s_waitcnt lgkmcnt(6)
v_mfma_f32_16x16x32_bf16 v[116:119], a[8:11], v[68:71], v[116:119]
ds_read_b128 v[60:63], v1 offset:20480
buffer_load_dwordx4 v1, s[4:7], s96 offen offset:2048 lds
v_mfma_f32_16x16x32_bf16 v[120:123], a[88:91], v[68:71], v[120:123]
v_mfma_f32_16x16x32_bf16 v[124:127], a[8:11], v[72:75], v[124:127]
ds_read_b128 v[64:67], v1 offset:21504
v_mfma_f32_16x16x32_bf16 v[128:131], a[88:91], v[72:75], v[128:131]
s_waitcnt lgkmcnt(6)
v_mfma_f32_16x16x32_bf16 v[132:135], a[8:11], v[76:79], v[132:135]
ds_read_b128 v[68:71], v1 offset:22528
buffer_load_dwordx4 v1, s[4:7], s96 offen offset:3072 lds
v_mfma_f32_16x16x32_bf16 v[136:139], a[88:91], v[76:79], v[136:139]
s_waitcnt vmcnt(16)
v_mfma_f32_16x16x32_bf16 v[100:103], a[12:15], v[80:83], v[100:103]
ds_read_b128 v[72:75], v1 offset:23552
s_waitcnt vmcnt(10)
v_add_f32 v24, v24, v26
v_add_f32 v25, v25, v27
v_mfma_f32_16x16x32_bf16 v[104:107], a[92:95], v[80:83], v[104:107]
s_waitcnt vmcnt(8)
v_add_f32 v28, v28, v30
s_waitcnt lgkmcnt(6)
v_mfma_f32_16x16x32_bf16 v[108:111], a[12:15], v[84:87], v[108:111]
ds_read_b128 v[76:79], v1 offset:24576
s_add_u32 s96, s36, 196608
s_add_u32 m0, s37, 65536
s_nop 0
buffer_load_dwordx4 v1, s[4:7], s96 offen offset:0 lds
v_mfma_f32_16x16x32_bf16 v[112:115], a[92:95], v[84:87], v[112:115]
v_mfma_f32_16x16x32_bf16 v[116:119], a[12:15], v[88:91], v[116:119]
ds_read_b128 v[80:83], v1 offset:25600
v_mfma_f32_16x16x32_bf16 v[120:123], a[92:95], v[88:91], v[120:123]
s_add_u32 s38, s99, 10625024
buffer_load_dwordx4 a[32:35], v1, s[4:7], s38 offen offset:0 sc1
s_waitcnt lgkmcnt(6)
v_mfma_f32_16x16x32_bf16 v[124:127], a[12:15], v[92:95], v[124:127]
ds_read_b128 v[84:87], v1 offset:26624
v_add_f32 v29, v29, v31
v_mfma_f32_16x16x32_bf16 v[128:131], a[92:95], v[92:95], v[128:131]
v_mov_b32 v236, v24
v_mfma_f32_16x16x32_bf16 v[132:135], a[12:15], v[96:99], v[132:135]
ds_read_b128 v[88:91], v1 offset:27648
v_mov_b32 v237, v25
v_mfma_f32_16x16x32_bf16 v[136:139], a[92:95], v[96:99], v[136:139]
s_add_u32 s39, s99, 10645504
buffer_load_dwordx4 a[112:115], v1, s[4:7], s39 offen offset:0 sc1
s_waitcnt lgkmcnt(6)
v_mfma_f32_16x16x32_bf16 v[100:103], a[16:19], v[60:63], v[100:103]
ds_read_b128 v[92:95], v1 offset:28672
v_mfma_f32_16x16x32_bf16 v[104:107], a[96:99], v[60:63], v[104:107]
v_mov_b32 v238, v28
v_mov_b32 v239, v29
v_mfma_f32_16x16x32_bf16 v[108:111], a[16:19], v[64:67], v[108:111]
ds_read_b128 v[96:99], v1 offset:29696
buffer_load_dwordx4 a[36:39], v1, s[4:7], s38 offen offset:1024 sc1
v_mfma_f32_16x16x32_bf16 v[112:115], a[96:99], v[64:67], v[112:115]
v_permlane32_swap_b32 v24, v236
s_waitcnt lgkmcnt(6)
v_mfma_f32_16x16x32_bf16 v[116:119], a[16:19], v[68:71], v[116:119]
ds_read_b128 v[60:63], v1 offset:30720
v_permlane32_swap_b32 v25, v237
v_mfma_f32_16x16x32_bf16 v[120:123], a[96:99], v[68:71], v[120:123]
v_permlane32_swap_b32 v28, v238
v_mfma_f32_16x16x32_bf16 v[124:127], a[16:19], v[72:75], v[124:127]
ds_read_b128 v[64:67], v1 offset:31744
buffer_load_dwordx4 a[116:119], v1, s[4:7], s39 offen offset:1024 sc1
v_mfma_f32_16x16x32_bf16 v[128:131], a[96:99], v[72:75], v[128:131]
v_permlane32_swap_b32 v29, v239
v_add_f32 v24, v24, v236
s_waitcnt lgkmcnt(6)
v_mfma_f32_16x16x32_bf16 v[132:135], a[16:19], v[76:79], v[132:135]
ds_read_b128 v[68:71], v1 offset:32768
v_mfma_f32_16x16x32_bf16 v[136:139], a[96:99], v[76:79], v[136:139]
buffer_load_dwordx4 a[40:43], v1, s[4:7], s38 offen offset:2048 sc1
v_add_f32 v25, v25, v237
v_mfma_f32_16x16x32_bf16 v[100:103], a[20:23], v[80:83], v[100:103]
ds_read_b128 v[72:75], v1 offset:33792
v_add_f32 v28, v28, v238
v_mfma_f32_16x16x32_bf16 v[104:107], a[100:103], v[80:83], v[104:107]
v_add_f32 v29, v29, v239
s_waitcnt lgkmcnt(6)
v_mfma_f32_16x16x32_bf16 v[108:111], a[20:23], v[84:87], v[108:111]
ds_read_b128 v[76:79], v1 offset:34816
v_mov_b32 v236, v24
v_mfma_f32_16x16x32_bf16 v[112:115], a[100:103], v[84:87], v[112:115]
buffer_load_dwordx4 a[120:123], v1, s[4:7], s39 offen offset:2048 sc1
v_mov_b32 v237, v25
v_mfma_f32_16x16x32_bf16 v[116:119], a[20:23], v[88:91], v[116:119]
ds_read_b128 v[80:83], v1 offset:35840
v_mfma_f32_16x16x32_bf16 v[120:123], a[100:103], v[88:91], v[120:123]
v_mov_b32 v238, v28
v_mov_b32 v239, v29
s_waitcnt lgkmcnt(6)
v_mfma_f32_16x16x32_bf16 v[124:127], a[20:23], v[92:95], v[124:127]
ds_read_b128 v[84:87], v1 offset:36864
v_permlane16_swap_b32 v24, v236
v_mfma_f32_16x16x32_bf16 v[128:131], a[100:103], v[92:95], v[128:131]
buffer_load_dwordx4 a[44:47], v1, s[4:7], s38 offen offset:3072 sc1
v_mfma_f32_16x16x32_bf16 v[132:135], a[20:23], v[96:99], v[132:135]
ds_read_b128 v[88:91], v1 offset:37888
v_permlane16_swap_b32 v25, v237
v_mfma_f32_16x16x32_bf16 v[136:139], a[100:103], v[96:99], v[136:139]
v_permlane16_swap_b32 v28, v238
s_waitcnt vmcnt(14) lgkmcnt(6)
v_mfma_f32_16x16x32_bf16 v[100:103], a[24:27], v[60:63], v[100:103]
ds_read_b128 v[92:95], v1 offset:38912
buffer_load_dwordx4 a[124:127], v1, s[4:7], s39 offen offset:3072 sc1
v_mfma_f32_16x16x32_bf16 v[104:107], a[104:107], v[60:63], v[104:107]
v_permlane16_swap_b32 v29, v239
v_add_f32 v24, v24, v236
v_mfma_f32_16x16x32_bf16 v[108:111], a[24:27], v[64:67], v[108:111]
ds_read_b128 v[96:99], v1 offset:39936
v_mfma_f32_16x16x32_bf16 v[112:115], a[104:107], v[64:67], v[112:115]
v_add_f32 v25, v25, v237
v_add_f32 v28, v28, v238
s_waitcnt lgkmcnt(6)
v_mfma_f32_16x16x32_bf16 v[116:119], a[24:27], v[68:71], v[116:119]
ds_read_b128 v[60:63], v1 offset:40960
s_add_u32 s96, s36, 212992
s_add_u32 m0, s37, 81920
s_nop 0
buffer_load_dwordx4 v1, s[4:7], s96 offen offset:0 lds
v_mfma_f32_16x16x32_bf16 v[120:123], a[104:107], v[68:71], v[120:123]
v_mfma_f32_16x16x32_bf16 v[124:127], a[24:27], v[72:75], v[124:127]
ds_read_b128 v[64:67], v1 offset:41984
v_mfma_f32_16x16x32_bf16 v[128:131], a[104:107], v[72:75], v[128:131]
buffer_load_dwordx4 v1, s[4:7], s96 offen offset:1024 lds
v_add_f32 v29, v29, v239
s_waitcnt lgkmcnt(6)
v_mfma_f32_16x16x32_bf16 v[132:135], a[24:27], v[76:79], v[132:135]
ds_read_b128 v[68:71], v1 offset:43008
v_mfma_f32_16x16x32_bf16 v[136:139], a[104:107], v[76:79], v[136:139]
v_mul_f32 v24, 0xbacccccd, v24
v_mul_f32 v236, v24, v24
s_waitcnt vmcnt(15)
v_mfma_f32_16x16x32_bf16 v[100:103], a[28:31], v[80:83], v[100:103]
ds_read_b128 v[72:75], v1 offset:44032
v_mul_f32 v25, 0x3acccccd, v25
v_mfma_f32_16x16x32_bf16 v[104:107], a[108:111], v[80:83], v[104:107]
buffer_load_dwordx4 v1, s[4:7], s96 offen offset:2048 lds
s_waitcnt lgkmcnt(6)
v_mfma_f32_16x16x32_bf16 v[108:111], a[28:31], v[84:87], v[108:111]
ds_read_b128 v[76:79], v1 offset:45056
v_sub_f32 v25, v25, v236
v_mfma_f32_16x16x32_bf16 v[112:115], a[108:111], v[84:87], v[112:115]
v_max_f32 v25, 0, v25
v_add_f32 v25, 0x3727c5ac, v25
v_mfma_f32_16x16x32_bf16 v[116:119], a[28:31], v[88:91], v[116:119]
ds_read_b128 v[80:83], v1 offset:46080
buffer_load_dwordx4 v1, s[4:7], s96 offen offset:3072 lds
v_mfma_f32_16x16x32_bf16 v[120:123], a[108:111], v[88:91], v[120:123]
s_waitcnt lgkmcnt(6)
v_mfma_f32_16x16x32_bf16 v[124:127], a[28:31], v[92:95], v[124:127]
ds_read_b128 v[84:87], v1 offset:47104
v_rsq_f32 v40, v25
v_mfma_f32_16x16x32_bf16 v[128:131], a[108:111], v[92:95], v[128:131]
v_cvt_pk_bf16_f32 v32, v24, v24
v_mfma_f32_16x16x32_bf16 v[132:135], a[28:31], v[96:99], v[132:135]
ds_read_b128 v[88:91], v1 offset:48128
s_add_u32 s96, s36, 217088
s_add_u32 m0, s37, 86016
s_nop 0
buffer_load_dwordx4 v1, s[4:7], s96 offen offset:0 lds
v_mfma_f32_16x16x32_bf16 v[136:139], a[108:111], v[96:99], v[136:139]
s_waitcnt vmcnt(11) lgkmcnt(6)
v_mfma_f32_16x16x32_bf16 v[100:103], a[32:35], v[60:63], v[100:103]
ds_read_b128 v[92:95], v1 offset:49152
v_mfma_f32_16x16x32_bf16 v[104:107], a[112:115], v[60:63], v[104:107]
v_lshlrev_b32 v236, 16, v32
v_sub_f32 v236, v24, v236
v_mfma_f32_16x16x32_bf16 v[108:111], a[32:35], v[64:67], v[108:111]
ds_read_b128 v[96:99], v1 offset:50176
s_add_u32 s38, s99, 10629120
buffer_load_dwordx4 a[48:51], v1, s[4:7], s38 offen offset:0 sc1
v_mfma_f32_16x16x32_bf16 v[112:115], a[112:115], v[64:67], v[112:115]
s_waitcnt lgkmcnt(6)
v_mfma_f32_16x16x32_bf16 v[116:119], a[32:35], v[68:71], v[116:119]
ds_read_b128 v[60:63], v1 offset:51200
v_mfma_f32_16x16x32_bf16 v[120:123], a[112:115], v[68:71], v[120:123]
s_add_u32 s39, s99, 10649600
buffer_load_dwordx4 a[128:131], v1, s[4:7], s39 offen offset:0 sc1
v_mfma_f32_16x16x32_bf16 v[124:127], a[32:35], v[72:75], v[124:127]
ds_read_b128 v[64:67], v1 offset:52224
v_cvt_pk_bf16_f32 v33, v236, 0
v_mfma_f32_16x16x32_bf16 v[128:131], a[112:115], v[72:75], v[128:131]
v_mov_b32 v34, v32
s_waitcnt lgkmcnt(6)
v_mfma_f32_16x16x32_bf16 v[132:135], a[32:35], v[76:79], v[132:135]
ds_read_b128 v[68:71], v1 offset:53248
v_mov_b32 v35, v33
v_mfma_f32_16x16x32_bf16 v[136:139], a[112:115], v[76:79], v[136:139]
buffer_load_dwordx4 a[52:55], v1, s[4:7], s38 offen offset:1024 sc1
s_waitcnt vmcnt(12)
v_mfma_f32_16x16x32_bf16 v[100:103], a[36:39], v[80:83], v[100:103]
ds_read_b128 v[72:75], v1 offset:54272
v_mul_f32 v42, 0x3fb8aa3b, v40
v_mfma_f32_16x16x32_bf16 v[104:107], a[116:119], v[80:83], v[104:107]
ds_bpermute_b32 v44, v20, v40 offset:0
ds_bpermute_b32 v45, v20, v40 offset:4
s_waitcnt lgkmcnt(8)
v_mfma_f32_16x16x32_bf16 v[108:111], a[36:39], v[84:87], v[108:111]
ds_read_b128 v[76:79], v1 offset:55296
buffer_load_dwordx4 a[132:135], v1, s[4:7], s39 offen offset:1024 sc1
v_mfma_f32_16x16x32_bf16 v[112:115], a[116:119], v[84:87], v[112:115]
ds_bpermute_b32 v46, v20, v40 offset:8
v_mfma_f32_16x16x32_bf16 v[116:119], a[36:39], v[88:91], v[116:119]
ds_read_b128 v[80:83], v1 offset:56320
ds_bpermute_b32 v47, v20, v40 offset:12
v_mfma_f32_16x16x32_bf16 v[120:123], a[116:119], v[88:91], v[120:123]
v_mul_f32 v28, 0xbacccccd, v28
s_waitcnt lgkmcnt(10)
v_mfma_f32_16x16x32_bf16 v[124:127], a[36:39], v[92:95], v[124:127]
ds_read_b128 v[84:87], v1 offset:57344
buffer_load_dwordx4 a[56:59], v1, s[4:7], s38 offen offset:2048 sc1
v_mfma_f32_16x16x32_bf16 v[128:131], a[116:119], v[92:95], v[128:131]
v_mul_f32 v236, v28, v28
v_mul_f32 v29, 0x3acccccd, v29
v_mfma_f32_16x16x32_bf16 v[132:135], a[36:39], v[96:99], v[132:135]
ds_read_b128 v[88:91], v1 offset:58368
v_mfma_f32_16x16x32_bf16 v[136:139], a[116:119], v[96:99], v[136:139]
buffer_load_dwordx4 a[136:139], v1, s[4:7], s39 offen offset:2048 sc1
v_sub_f32 v29, v29, v236
s_waitcnt vmcnt(13) lgkmcnt(10)
v_mfma_f32_16x16x32_bf16 v[100:103], a[40:43], v[60:63], v[100:103]
ds_read_b128 v[92:95], v1 offset:59392
v_max_f32 v29, 0, v29
v_mfma_f32_16x16x32_bf16 v[104:107], a[120:123], v[60:63], v[104:107]
v_add_f32 v29, 0x3727c5ac, v29
v_mfma_f32_16x16x32_bf16 v[108:111], a[40:43], v[64:67], v[108:111]
ds_read_b128 v[96:99], v1 offset:60416
v_mfma_f32_16x16x32_bf16 v[112:115], a[120:123], v[64:67], v[112:115]
s_barrier
buffer_load_dwordx4 a[60:63], v1, s[4:7], s38 offen offset:3072 sc1
s_waitcnt lgkmcnt(10)
v_mfma_f32_16x16x32_bf16 v[116:119], a[40:43], v[68:71], v[116:119]
ds_read_b128 v[60:63], v1 offset:61440
v_mfma_f32_16x16x32_bf16 v[120:123], a[120:123], v[68:71], v[120:123]
v_rsq_f32 v41, v29
v_mfma_f32_16x16x32_bf16 v[124:127], a[40:43], v[72:75], v[124:127]
ds_read_b128 v[64:67], v1 offset:62464
v_mfma_f32_16x16x32_bf16 v[128:131], a[120:123], v[72:75], v[128:131]
buffer_load_dwordx4 a[140:143], v1, s[4:7], s39 offen offset:3072 sc1
v_cvt_pk_bf16_f32 v36, v28, v28
s_waitcnt lgkmcnt(7)
v_mfma_f32_16x16x32_bf16 v[132:135], a[40:43], v[76:79], v[132:135]
ds_read_b128 v[68:71], v1 offset:63488
v_lshlrev_b32 v236, 16, v36
v_mfma_f32_16x16x32_bf16 v[136:139], a[120:123], v[76:79], v[136:139]
v_sub_f32 v236, v28, v236
s_waitcnt vmcnt(13)
v_mfma_f32_16x16x32_bf16 v[100:103], a[44:47], v[80:83], v[100:103]
ds_read_b128 v[72:75], v1 offset:64512
s_add_u32 s38, s99, 10633216
buffer_load_dwordx4 a[64:67], v1, s[4:7], s38 offen offset:0 sc1
v_mfma_f32_16x16x32_bf16 v[104:107], a[124:127], v[80:83], v[104:107]
s_waitcnt lgkmcnt(6)
v_mfma_f32_16x16x32_bf16 v[108:111], a[44:47], v[84:87], v[108:111]
ds_read_b128 v[76:79], v2 offset:0
v_cvt_pk_bf16_f32 v37, v236, 0
v_mfma_f32_16x16x32_bf16 v[112:115], a[124:127], v[84:87], v[112:115]
v_mov_b32 v38, v36
v_mov_b32 v39, v37
v_mfma_f32_16x16x32_bf16 v[116:119], a[44:47], v[88:91], v[116:119]
ds_read_b128 v[80:83], v2 offset:1024
s_add_u32 s39, s99, 10653696
buffer_load_dwordx4 a[144:147], v1, s[4:7], s39 offen offset:0 sc1
v_mfma_f32_16x16x32_bf16 v[120:123], a[124:127], v[88:91], v[120:123]
s_waitcnt lgkmcnt(6)
v_mfma_f32_16x16x32_bf16 v[124:127], a[44:47], v[92:95], v[124:127]
ds_read_b128 v[84:87], v2 offset:2048
v_mul_f32 v43, 0x3fb8aa3b, v41
v_mfma_f32_16x16x32_bf16 v[128:131], a[124:127], v[92:95], v[128:131]
buffer_load_dwordx4 a[68:71], v1, s[4:7], s38 offen offset:1024 sc1
v_mfma_f32_16x16x32_bf16 v[132:135], a[44:47], v[96:99], v[132:135]
ds_read_b128 v[88:91], v2 offset:3072
ds_bpermute_b32 v48, v20, v41 offset:0
v_mfma_f32_16x16x32_bf16 v[136:139], a[124:127], v[96:99], v[136:139]
ds_bpermute_b32 v49, v20, v41 offset:4
s_waitcnt vmcnt(9) lgkmcnt(8)
v_mfma_f32_16x16x32_bf16 v[100:103], a[48:51], v[60:63], v[100:103]
ds_read_b128 v[92:95], v2 offset:4096
ds_bpermute_b32 v50, v20, v41 offset:8
v_mfma_f32_16x16x32_bf16 v[104:107], a[128:131], v[60:63], v[104:107]
buffer_load_dwordx4 a[148:151], v1, s[4:7], s39 offen offset:1024 sc1
ds_bpermute_b32 v51, v20, v41 offset:12
v_mfma_f32_16x16x32_bf16 v[108:111], a[48:51], v[64:67], v[108:111]
ds_read_b128 v[96:99], v2 offset:5120
v_mfma_f32_16x16x32_bf16 v[112:115], a[128:131], v[64:67], v[112:115]
v_mul_f32 v52, 0x3fb8aa3b, v44
v_mul_f32 v53, 0x3fb8aa3b, v45
s_waitcnt lgkmcnt(10)
v_mfma_f32_16x16x32_bf16 v[116:119], a[48:51], v[68:71], v[116:119]
ds_read_b128 v[60:63], v2 offset:6144
buffer_load_dwordx4 a[72:75], v1, s[4:7], s38 offen offset:2048 sc1
v_mfma_f32_16x16x32_bf16 v[120:123], a[128:131], v[68:71], v[120:123]
v_mul_f32 v54, 0x3fb8aa3b, v46
v_mfma_f32_16x16x32_bf16 v[124:127], a[48:51], v[72:75], v[124:127]
ds_read_b128 v[64:67], v2 offset:7168
v_mul_f32 v55, 0x3fb8aa3b, v47
v_mfma_f32_16x16x32_bf16 v[128:131], a[128:131], v[72:75], v[128:131]
s_waitcnt lgkmcnt(7)
v_mul_f32 v56, 0x3fb8aa3b, v48
s_waitcnt lgkmcnt(6)
v_mul_f32 v57, 0x3fb8aa3b, v49
v_mfma_f32_16x16x32_bf16 v[132:135], a[48:51], v[76:79], v[132:135]
ds_read_b128 v[68:71], v2 offset:8192
buffer_load_dwordx4 a[152:155], v1, s[4:7], s39 offen offset:2048 sc1
v_mfma_f32_16x16x32_bf16 v[136:139], a[128:131], v[76:79], v[136:139]
s_waitcnt lgkmcnt(5)
v_mul_f32 v58, 0x3fb8aa3b, v50
s_waitcnt vmcnt(10)
v_mfma_f32_16x16x32_bf16 v[100:103], a[52:55], v[80:83], v[100:103]
ds_read_b128 v[72:75], v2 offset:9216
s_waitcnt lgkmcnt(5)
v_mul_f32 v59, 0x3fb8aa3b, v51
v_mfma_f32_16x16x32_bf16 v[104:107], a[132:135], v[80:83], v[104:107]
s_lshl_b32 s22, s16, 12
v_mfma_f32_16x16x32_bf16 v[108:111], a[52:55], v[84:87], v[108:111]
ds_read_b128 v[76:79], v2 offset:10240
buffer_load_dwordx4 a[76:79], v1, s[4:7], s38 offen offset:3072 sc1
v_mfma_f32_16x16x32_bf16 v[112:115], a[132:135], v[84:87], v[112:115]
v_add_u32 v246, s22, v1
s_lshl_b32 s22, s16, 10
v_mfma_f32_16x16x32_bf16 v[116:119], a[52:55], v[88:91], v[116:119]
ds_read_b128 v[80:83], v2 offset:11264
v_mfma_f32_16x16x32_bf16 v[120:123], a[132:135], v[88:91], v[120:123]
buffer_load_dwordx4 a[156:159], v1, s[4:7], s39 offen offset:3072 sc1
v_add_u32 v247, s22, v1
s_waitcnt lgkmcnt(6)
v_mfma_f32_16x16x32_bf16 v[124:127], a[52:55], v[92:95], v[124:127]
ds_read_b128 v[84:87], v2 offset:12288
s_lshl_b32 s25, s18, 15
v_mfma_f32_16x16x32_bf16 v[128:131], a[132:135], v[92:95], v[128:131]
s_lshl_b32 s22, s16, 13
v_mfma_f32_16x16x32_bf16 v[132:135], a[52:55], v[96:99], v[132:135]
ds_read_b128 v[88:91], v2 offset:13312
s_add_u32 s25, s25, s22
v_mfma_f32_16x16x32_bf16 v[136:139], a[132:135], v[96:99], v[136:139]
s_add_u32 s38, s100, 2752512
buffer_load_dwordx4 a[160:163], v1, s[4:7], s38 offen offset:0 sc1
s_waitcnt vmcnt(11) lgkmcnt(6)
v_mfma_f32_16x16x32_bf16 v[100:103], a[56:59], v[60:63], v[100:103]
ds_read_b128 v[92:95], v2 offset:14336
v_mfma_f32_16x16x32_bf16 v[104:107], a[136:139], v[60:63], v[104:107]
s_lshl_b32 s22, s19, 20
s_add_u32 s25, s25, s22
v_mfma_f32_16x16x32_bf16 v[108:111], a[56:59], v[64:67], v[108:111]
ds_read_b128 v[96:99], v2 offset:15360
buffer_load_dwordx4 a[164:167], v1, s[4:7], s38 offen offset:1024 sc1
v_mfma_f32_16x16x32_bf16 v[112:115], a[136:139], v[64:67], v[112:115]
s_barrier
s_waitcnt lgkmcnt(6)
v_mfma_f32_16x16x32_bf16 v[116:119], a[56:59], v[68:71], v[116:119]
ds_read_b128 v[60:63], v2 offset:16384
v_mfma_f32_16x16x32_bf16 v[120:123], a[136:139], v[68:71], v[120:123]
s_add_u32 s27, s25, 41549824
v_mfma_f32_16x16x32_bf16 v[124:127], a[56:59], v[72:75], v[124:127]
ds_read_b128 v[64:67], v2 offset:17408
buffer_load_dwordx4 a[168:171], v1, s[4:7], s38 offen offset:2048 sc1
v_mfma_f32_16x16x32_bf16 v[128:131], a[136:139], v[72:75], v[128:131]
s_lshl_b32 s22, s17, 9
s_add_u32 s25, s22, s27
s_waitcnt lgkmcnt(6)
v_mfma_f32_16x16x32_bf16 v[132:135], a[56:59], v[76:79], v[132:135]
ds_read_b128 v[68:71], v2 offset:18432
v_mfma_f32_16x16x32_bf16 v[136:139], a[136:139], v[76:79], v[136:139]
buffer_load_dwordx4 a[172:175], v1, s[4:7], s38 offen offset:3072 sc1
v_lshlrev_b32 v248, 3, v0
s_waitcnt vmcnt(12)
v_mfma_f32_16x16x32_bf16 v[100:103], a[60:63], v[80:83], v[100:103]
ds_read_b128 v[72:75], v2 offset:19456
v_and_b32 v249, 8, v17
v_mfma_f32_16x16x32_bf16 v[104:107], a[140:143], v[80:83], v[104:107]
v_lshl_add_u32 v249, v249, 27, v17
s_waitcnt lgkmcnt(6)
v_mfma_f32_16x16x32_bf16 v[108:111], a[60:63], v[84:87], v[108:111]
ds_read_b128 v[76:79], v2 offset:20480
v_mfma_f32_16x16x32_bf16 v[112:115], a[140:143], v[84:87], v[112:115]
s_add_u32 s38, s100, 2756608
buffer_load_dwordx4 a[176:179], v1, s[4:7], s38 offen offset:0 sc1
v_mfma_f32_16x16x32_bf16 v[116:119], a[60:63], v[88:91], v[116:119]
ds_read_b128 v[80:83], v2 offset:21504
v_mfma_f32_16x16x32_bf16 v[120:123], a[140:143], v[88:91], v[120:123]
s_waitcnt lgkmcnt(6)
v_mfma_f32_16x16x32_bf16 v[124:127], a[60:63], v[92:95], v[124:127]
ds_read_b128 v[84:87], v2 offset:22528
v_mfma_f32_16x16x32_bf16 v[128:131], a[140:143], v[92:95], v[128:131]
s_add_u32 s39, s34, 233472
s_add_u32 m0, s35, 102400
s_nop 0
buffer_load_dwordx4 v1, s[4:7], s39 offen offset:0 lds
v_mfma_f32_16x16x32_bf16 v[132:135], a[60:63], v[96:99], v[132:135]
ds_read_b128 v[88:91], v2 offset:23552
v_mfma_f32_16x16x32_bf16 v[136:139], a[140:143], v[96:99], v[136:139]
s_waitcnt vmcnt(12) lgkmcnt(6)
v_mfma_f32_16x16x32_bf16 v[100:103], a[64:67], v[60:63], v[100:103]
ds_read_b128 v[92:95], v2 offset:24576
buffer_load_dwordx4 v1, s[4:7], s39 offen offset:1024 lds
v_mfma_f32_16x16x32_bf16 v[104:107], a[144:147], v[60:63], v[104:107]
v_mfma_f32_16x16x32_bf16 v[108:111], a[64:67], v[64:67], v[108:111]
ds_read_b128 v[96:99], v2 offset:25600
v_mfma_f32_16x16x32_bf16 v[112:115], a[144:147], v[64:67], v[112:115]
s_waitcnt lgkmcnt(6)
v_mfma_f32_16x16x32_bf16 v[116:119], a[64:67], v[68:71], v[116:119]
ds_read_b128 v[60:63], v2 offset:26624
buffer_load_dwordx4 v1, s[4:7], s39 offen offset:2048 lds
v_mfma_f32_16x16x32_bf16 v[120:123], a[144:147], v[68:71], v[120:123]
v_mfma_f32_16x16x32_bf16 v[124:127], a[64:67], v[72:75], v[124:127]
ds_read_b128 v[64:67], v2 offset:27648
v_mfma_f32_16x16x32_bf16 v[128:131], a[144:147], v[72:75], v[128:131]
buffer_load_dwordx4 v1, s[4:7], s39 offen offset:3072 lds
s_waitcnt lgkmcnt(6)
v_mfma_f32_16x16x32_bf16 v[132:135], a[64:67], v[76:79], v[132:135]
ds_read_b128 v[68:71], v2 offset:28672
v_mfma_f32_16x16x32_bf16 v[136:139], a[144:147], v[76:79], v[136:139]
s_waitcnt vmcnt(13)
v_mfma_f32_16x16x32_bf16 v[100:103], a[68:71], v[80:83], v[100:103]
ds_read_b128 v[72:75], v2 offset:29696
v_mfma_f32_16x16x32_bf16 v[104:107], a[148:151], v[80:83], v[104:107]
s_add_u32 s39, s34, 237568
s_add_u32 m0, s35, 106496
s_nop 0
buffer_load_dwordx4 v1, s[4:7], s39 offen offset:0 lds
s_waitcnt lgkmcnt(6)
v_mfma_f32_16x16x32_bf16 v[108:111], a[68:71], v[84:87], v[108:111]
ds_read_b128 v[76:79], v2 offset:30720
v_mfma_f32_16x16x32_bf16 v[112:115], a[148:151], v[84:87], v[112:115]
v_mfma_f32_16x16x32_bf16 v[116:119], a[68:71], v[88:91], v[116:119]
ds_read_b128 v[80:83], v2 offset:31744
buffer_load_dwordx4 v1, s[4:7], s39 offen offset:1024 lds
v_mfma_f32_16x16x32_bf16 v[120:123], a[148:151], v[88:91], v[120:123]
s_waitcnt lgkmcnt(6)
v_mfma_f32_16x16x32_bf16 v[124:127], a[68:71], v[92:95], v[124:127]
ds_read_b128 v[84:87], v2 offset:32768
v_mfma_f32_16x16x32_bf16 v[128:131], a[148:151], v[92:95], v[128:131]
v_mfma_f32_16x16x32_bf16 v[132:135], a[68:71], v[96:99], v[132:135]
ds_read_b128 v[88:91], v2 offset:33792
buffer_load_dwordx4 v1, s[4:7], s39 offen offset:2048 lds
v_mfma_f32_16x16x32_bf16 v[136:139], a[148:151], v[96:99], v[136:139]
s_waitcnt vmcnt(14) lgkmcnt(6)
v_mfma_f32_16x16x32_bf16 v[100:103], a[72:75], v[60:63], v[100:103]
ds_read_b128 v[92:95], v2 offset:34816
v_mfma_f32_16x16x32_bf16 v[104:107], a[152:155], v[60:63], v[104:107]
v_mfma_f32_16x16x32_bf16 v[108:111], a[72:75], v[64:67], v[108:111]
ds_read_b128 v[96:99], v2 offset:35840
buffer_load_dwordx4 v1, s[4:7], s39 offen offset:3072 lds
v_mfma_f32_16x16x32_bf16 v[112:115], a[152:155], v[64:67], v[112:115]
s_waitcnt lgkmcnt(6)
v_mfma_f32_16x16x32_bf16 v[116:119], a[72:75], v[68:71], v[116:119]
v_mfma_f32_16x16x32_bf16 v[120:123], a[152:155], v[68:71], v[120:123]
s_add_u32 s39, s34, 241664
s_add_u32 m0, s35, 110592
s_nop 0
buffer_load_dwordx4 v1, s[4:7], s39 offen offset:0 lds
v_mfma_f32_16x16x32_bf16 v[124:127], a[72:75], v[72:75], v[124:127]
v_mfma_f32_16x16x32_bf16 v[128:131], a[152:155], v[72:75], v[128:131]
s_waitcnt lgkmcnt(4)
v_mfma_f32_16x16x32_bf16 v[132:135], a[72:75], v[76:79], v[132:135]
v_mfma_f32_16x16x32_bf16 v[136:139], a[152:155], v[76:79], v[136:139]
buffer_load_dwordx4 v1, s[4:7], s39 offen offset:1024 lds
s_waitcnt vmcnt(15)
v_mfma_f32_16x16x32_bf16 v[100:103], a[76:79], v[80:83], v[100:103]
v_mfma_f32_16x16x32_bf16 v[104:107], a[156:159], v[80:83], v[104:107]
s_waitcnt lgkmcnt(2)
v_mfma_f32_16x16x32_bf16 v[108:111], a[76:79], v[84:87], v[108:111]
buffer_load_dwordx4 v1, s[4:7], s39 offen offset:2048 lds
v_mfma_f32_16x16x32_bf16 v[112:115], a[156:159], v[84:87], v[112:115]
v_mfma_f32_16x16x32_bf16 v[116:119], a[76:79], v[88:91], v[116:119]
v_mfma_f32_16x16x32_bf16 v[120:123], a[156:159], v[88:91], v[120:123]
s_waitcnt lgkmcnt(0)
v_mfma_f32_16x16x32_bf16 v[124:127], a[76:79], v[92:95], v[124:127]
buffer_load_dwordx4 v1, s[4:7], s39 offen offset:3072 lds
v_mfma_f32_16x16x32_bf16 v[128:131], a[156:159], v[92:95], v[128:131]
v_mfma_f32_16x16x32_bf16 v[132:135], a[76:79], v[96:99], v[132:135]
v_mfma_f32_16x16x32_bf16 v[136:139], a[156:159], v[96:99], v[136:139]
s_add_u32 s39, s34, 245760
s_add_u32 m0, s35, 114688
s_nop 0
buffer_load_dwordx4 v1, s[4:7], s39 offen offset:0 lds
s_waitcnt vmcnt(17)
v_mfma_f32_16x16x32_bf16 v[100:103], v[32:35], a[160:163], v[100:103]
v_mfma_f32_16x16x32_bf16 v[104:107], v[36:39], a[160:163], v[104:107]
s_waitcnt vmcnt(16)
v_mfma_f32_16x16x32_bf16 v[108:111], v[32:35], a[164:167], v[108:111]
v_mfma_f32_16x16x32_bf16 v[112:115], v[36:39], a[164:167], v[112:115]
s_waitcnt vmcnt(15)
v_mfma_f32_16x16x32_bf16 v[116:119], v[32:35], a[168:171], v[116:119]
v_mfma_f32_16x16x32_bf16 v[120:123], v[36:39], a[168:171], v[120:123]
s_waitcnt vmcnt(14)
v_mfma_f32_16x16x32_bf16 v[124:127], v[32:35], a[172:175], v[124:127]
v_mfma_f32_16x16x32_bf16 v[128:131], v[36:39], a[172:175], v[128:131]
s_waitcnt vmcnt(13)
v_mfma_f32_16x16x32_bf16 v[132:135], v[32:35], a[176:179], v[132:135]
v_mfma_f32_16x16x32_bf16 v[136:139], v[36:39], a[176:179], v[136:139]
s_or_b32 s23, s16, s19
s_cmp_eq_u32 s23, 0
s_cbranch_scc0 L_if21
buffer_load_dword v23, v254, s[4:7], s101 offen sc1
L_if21:
v_mov_b32 v184, 0x358637bd
v_pk_mul_f32 v[236:237], v[100:101], v[52:53]
v_pk_mul_f32 v[238:239], v[102:103], v[54:55]
v_pk_fma_f32 v[100:101], v[100:101], v[44:45], v[184:185] op_sel_hi:[1,1,0]
v_pk_fma_f32 v[102:103], v[102:103], v[46:47], v[184:185] op_sel_hi:[1,1,0]
v_exp_f32 v236, v236 clamp
v_exp_f32 v237, v237 clamp
buffer_load_dwordx4 v1, s[4:7], s39 offen offset:1024 lds
v_exp_f32 v238, v238 clamp
v_exp_f32 v239, v239 clamp
v_max_f32 v100, 0x358637bd, v100
v_max_f32 v101, 0x358637bd, v101
v_max_f32 v102, 0x358637bd, v102
v_max_f32 v103, 0x358637bd, v103
v_pk_add_f32 v[100:101], v[100:101], v[236:237]
buffer_load_dwordx4 v1, s[4:7], s39 offen offset:2048 lds
v_pk_add_f32 v[102:103], v[102:103], v[238:239]
v_cvt_pk_bf16_f32 v164, v100, v101
v_cvt_pk_bf16_f32 v165, v102, v103
v_pk_mul_f32 v[236:237], v[104:105], v[56:57]
v_pk_mul_f32 v[238:239], v[106:107], v[58:59]
v_pk_fma_f32 v[104:105], v[104:105], v[48:49], v[184:185] op_sel_hi:[1,1,0]
s_add_u32 s38, s100, 2757632
buffer_load_dwordx4 a[180:183], v1, s[4:7], s38 offen offset:0 sc1
v_pk_fma_f32 v[106:107], v[106:107], v[50:51], v[184:185] op_sel_hi:[1,1,0]
v_exp_f32 v236, v236 clamp
v_exp_f32 v237, v237 clamp
v_exp_f32 v238, v238 clamp
v_exp_f32 v239, v239 clamp
v_max_f32 v104, 0x358637bd, v104
v_max_f32 v105, 0x358637bd, v105
buffer_load_dwordx4 a[184:187], v1, s[4:7], s38 offen offset:1024 sc1
v_max_f32 v106, 0x358637bd, v106
v_max_f32 v107, 0x358637bd, v107
v_pk_add_f32 v[104:105], v[104:105], v[236:237]
v_pk_add_f32 v[106:107], v[106:107], v[238:239]
v_cvt_pk_bf16_f32 v166, v104, v105
v_cvt_pk_bf16_f32 v167, v106, v107
v_pk_mul_f32 v[236:237], v[108:109], v[52:53]
buffer_load_dwordx4 a[188:191], v1, s[4:7], s38 offen offset:2048 sc1
v_pk_mul_f32 v[238:239], v[110:111], v[54:55]
v_pk_fma_f32 v[108:109], v[108:109], v[44:45], v[184:185] op_sel_hi:[1,1,0]
v_pk_fma_f32 v[110:111], v[110:111], v[46:47], v[184:185] op_sel_hi:[1,1,0]
v_exp_f32 v236, v236 clamp
v_exp_f32 v237, v237 clamp
v_exp_f32 v238, v238 clamp
v_exp_f32 v239, v239 clamp
v_max_f32 v108, 0x358637bd, v108
v_max_f32 v109, 0x358637bd, v109
v_max_f32 v110, 0x358637bd, v110
v_max_f32 v111, 0x358637bd, v111
v_pk_add_f32 v[108:109], v[108:109], v[236:237]
v_pk_add_f32 v[110:111], v[110:111], v[238:239]
v_cvt_pk_bf16_f32 v168, v108, v109
v_cvt_pk_bf16_f32 v169, v110, v111
v_pk_mul_f32 v[236:237], v[112:113], v[56:57]
v_pk_mul_f32 v[238:239], v[114:115], v[58:59]
v_pk_fma_f32 v[112:113], v[112:113], v[48:49], v[184:185] op_sel_hi:[1,1,0]
v_pk_fma_f32 v[114:115], v[114:115], v[50:51], v[184:185] op_sel_hi:[1,1,0]
v_exp_f32 v236, v236 clamp
v_exp_f32 v237, v237 clamp
v_exp_f32 v238, v238 clamp
v_exp_f32 v239, v239 clamp
v_max_f32 v112, 0x358637bd, v112
v_max_f32 v113, 0x358637bd, v113
v_max_f32 v114, 0x358637bd, v114
v_max_f32 v115, 0x358637bd, v115
v_pk_add_f32 v[112:113], v[112:113], v[236:237]
v_pk_add_f32 v[114:115], v[114:115], v[238:239]
v_cvt_pk_bf16_f32 v170, v112, v113
v_cvt_pk_bf16_f32 v171, v114, v115
v_pk_mul_f32 v[236:237], v[116:117], v[52:53]
v_pk_mul_f32 v[238:239], v[118:119], v[54:55]
v_pk_mul_f32 v[240:241], v[116:117], v[44:45]
v_pk_mul_f32 v[242:243], v[118:119], v[46:47]
v_pk_fma_f32 v[116:117], v[116:117], v[44:45], v[184:185] op_sel_hi:[1,1,0]
v_pk_fma_f32 v[118:119], v[118:119], v[46:47], v[184:185] op_sel_hi:[1,1,0]
v_exp_f32 v236, v236 clamp
v_exp_f32 v237, v237 clamp
v_exp_f32 v238, v238 clamp
v_exp_f32 v239, v239 clamp
v_max_f32 v116, 0x358637bd, v116
v_max_f32 v117, 0x358637bd, v117
v_max_f32 v118, 0x358637bd, v118
v_max_f32 v119, 0x358637bd, v119
v_pk_add_f32 v[116:117], v[116:117], v[236:237]
v_pk_add_f32 v[118:119], v[118:119], v[238:239]
v_cndmask_b32 v116, v240, v116, s[44:45]
v_cndmask_b32 v117, v241, v117, s[44:45]
v_cndmask_b32 v118, v242, v118, s[44:45]
v_cndmask_b32 v119, v243, v119, s[44:45]
v_cvt_pk_bf16_f32 v172, v116, v117
v_cvt_pk_bf16_f32 v173, v118, v119
v_pk_mul_f32 v[236:237], v[120:121], v[56:57]
v_pk_mul_f32 v[238:239], v[122:123], v[58:59]
v_pk_mul_f32 v[240:241], v[120:121], v[48:49]
v_pk_mul_f32 v[242:243], v[122:123], v[50:51]
v_pk_fma_f32 v[120:121], v[120:121], v[48:49], v[184:185] op_sel_hi:[1,1,0]
v_pk_fma_f32 v[122:123], v[122:123], v[50:51], v[184:185] op_sel_hi:[1,1,0]
v_exp_f32 v236, v236 clamp
v_exp_f32 v237, v237 clamp
v_exp_f32 v238, v238 clamp
v_exp_f32 v239, v239 clamp
v_max_f32 v120, 0x358637bd, v120
v_max_f32 v121, 0x358637bd, v121
v_max_f32 v122, 0x358637bd, v122
v_max_f32 v123, 0x358637bd, v123
v_pk_add_f32 v[120:121], v[120:121], v[236:237]
v_pk_add_f32 v[122:123], v[122:123], v[238:239]
v_cndmask_b32 v120, v240, v120, s[44:45]
v_cndmask_b32 v121, v241, v121, s[44:45]
v_cndmask_b32 v122, v242, v122, s[44:45]
v_cndmask_b32 v123, v243, v123, s[44:45]
v_cvt_pk_bf16_f32 v174, v120, v121
v_cvt_pk_bf16_f32 v175, v122, v123
v_pk_mul_f32 v[124:125], v[124:125], v[44:45]
v_pk_mul_f32 v[126:127], v[126:127], v[46:47]
v_cvt_pk_bf16_f32 v176, v124, v125
v_cvt_pk_bf16_f32 v177, v126, v127
v_pk_mul_f32 v[128:129], v[128:129], v[48:49]
v_pk_mul_f32 v[130:131], v[130:131], v[50:51]
v_cvt_pk_bf16_f32 v178, v128, v129
v_cvt_pk_bf16_f32 v179, v130, v131
v_pk_mul_f32 v[132:133], v[132:133], v[44:45]
v_pk_mul_f32 v[134:135], v[134:135], v[46:47]
v_cvt_pk_bf16_f32 v180, v132, v133
v_cvt_pk_bf16_f32 v181, v134, v135
v_pk_mul_f32 v[136:137], v[136:137], v[48:49]
v_pk_mul_f32 v[138:139], v[138:139], v[50:51]
v_cvt_pk_bf16_f32 v182, v136, v137
v_cvt_pk_bf16_f32 v183, v138, v139
v_mov_b32 v236, 0x3f803f80
v_cndmask_b32 v184, v172, v236, s[44:45]
v_cndmask_b32 v185, v173, v236, s[44:45]
v_cndmask_b32 v186, v174, v236, s[44:45]
v_cndmask_b32 v187, v175, v236, s[44:45]
v_mov_b32_dpp v172, v172 row_shr:8 row_mask:0xf bank_mask:0xc
v_mov_b32_dpp v173, v173 row_shr:8 row_mask:0xf bank_mask:0xc
v_mov_b32_dpp v174, v174 row_shr:8 row_mask:0xf bank_mask:0xc
v_mov_b32_dpp v175, v175 row_shr:8 row_mask:0xf bank_mask:0xc
v_mfma_f32_16x16x32_bf16 v[200:203], v[164:167], v[184:187], 0
v_mfma_f32_16x16x32_bf16 v[204:207], v[168:171], v[184:187], 0
v_mfma_f32_16x16x32_bf16 v[208:211], v[172:175], v[176:179], 0
v_mfma_f32_16x16x32_bf16 v[212:215], v[172:175], v[180:183], 0
v_mfma_f32_16x16x32_bf16 v[216:219], v[172:175], v[184:187], 0
v_mfma_f32_16x16x32_bf16 v[192:195], v[164:167], v[176:179], 0
v_mfma_f32_16x16x32_bf16 v[196:199], v[168:171], v[180:183], 0
s_nop 2
v_cndmask_b32 v200, v200, v204, s[46:47]
v_cndmask_b32 v201, v201, v205, s[46:47]
v_cndmask_b32 v202, v202, v206, s[46:47]
v_cndmask_b32 v203, v203, v207, s[46:47]
v_cndmask_b32 v216, v216, v208, s[40:41]
v_cndmask_b32 v217, v217, v209, s[40:41]
v_cndmask_b32 v218, v218, v210, s[40:41]
v_cndmask_b32 v219, v219, v211, s[40:41]
v_cndmask_b32 v216, v216, v212, s[42:43]
v_cndmask_b32 v217, v217, v213, s[42:43]
v_cndmask_b32 v218, v218, v214, s[42:43]
v_cndmask_b32 v219, v219, v215, s[42:43]
ds_write_b128 v246, v[192:195] offset:0
ds_write_b128 v246, v[196:199] offset:1024
ds_write_b128 v246, v[200:203] offset:2048
ds_write_b128 v246, v[216:219] offset:3072
s_waitcnt lgkmcnt(0)
s_barrier
ds_read_b128 v[164:167], v247 offset:0
ds_read_b128 v[168:171], v247 offset:4096
ds_read_b128 v[172:175], v247 offset:8192
ds_read_b128 v[176:179], v247 offset:12288
s_waitcnt lgkmcnt(2)
v_pk_add_f32 v[164:165], v[164:165], v[168:169]
v_pk_add_f32 v[166:167], v[166:167], v[170:171]
s_waitcnt lgkmcnt(0)
v_pk_add_f32 v[172:173], v[172:173], v[176:177]
v_pk_add_f32 v[174:175], v[174:175], v[178:179]
v_pk_add_f32 v[164:165], v[164:165], v[172:173]
v_pk_add_f32 v[166:167], v[166:167], v[174:175]
v_cvt_pk_bf16_f32 v164, v164, v165
v_cvt_pk_bf16_f32 v165, v166, v167
v_mov_b32 v166, v164
v_mov_b32 v167, v165
s_nop 0
v_permlane16_swap_b32 v164, v166
v_permlane16_swap_b32 v165, v167
buffer_store_dwordx4 v[164:167], v249, s[4:7], s25 offen sc1
s_cmp_eq_u32 s19, 0
s_cbranch_scc0 L_if22
s_mul_i32 s22, s32, 20480
s_mul_i32 s23, s21, 2560
s_add_u32 s22, s22, s23
s_add_u32 s22, s22, 10616832
buffer_load_dwordx4 v[4:7], v1, s[4:7], s22 offen
buffer_load_dwordx4 v[8:11], v1, s[4:7], s22 offen offset:1024
buffer_load_dwordx2 v[12:13], v17, s[4:7], s22 offen offset:2048
L_if22:
s_or_b32 s23, s16, s19
s_cmp_eq_u32 s23, 0
s_cbranch_scc0 L_if23
s_mov_b32 s22, s94
s_waitcnt vmcnt(9)
v_cmp_eq_u32 vcc, s92, v23
s_mov_b32 s33, 0
L_slot1:
s_and_b32 s23, vcc_lo, s22
s_cmp_eq_u32 s23, s22
s_cbranch_scc1 L_slotd1
buffer_load_dword v23, v254, s[4:7], s101 offen sc1
s_waitcnt vmcnt(0)
v_cmp_eq_u32 vcc, s92, v23
s_add_u32 s33, s33, 1
s_cmp_lt_u32 s33, 100000
s_cbranch_scc1 L_slot1
L_slotd1:
L_if23:
s_waitcnt vmcnt(4)
s_barrier
ds_read_b128 v[60:63], v2 offset:36864
ds_read_b128 v[64:67], v2 offset:39936
ds_read_b128 v[68:71], v2 offset:43008
ds_read_b128 v[72:75], v2 offset:46080
ds_read_b128 v[76:79], v2 offset:49152
ds_read_b128 v[80:83], v2 offset:52224
ds_read_b128 v[84:87], v2 offset:55296
ds_read_b128 v[88:91], v2 offset:58368
s_mul_i32 s98, s21, 102400
s_mul_i32 s22, s16, 25600
s_add_u32 s98, s98, s22
s_mul_i32 s37, s16, 7168
s_mul_i32 s36, s18, 286720
s_add_u32 s36, s36, s37
s_mul_i32 s12, s18, 7168
s_min_u32 s13, s18, 14
s_mul_i32 s13, s13, 7168
s_mul_i32 s14, s21, 276480
s_mul_i32 s15, s16, 40960
s_add_u32 s14, s14, s15
s_waitcnt lgkmcnt(6)
v_mfma_f32_16x16x32_bf16 v[140:143], v[60:63], a[0:3], 0
ds_read_b128 v[92:95], v2 offset:61440
v_mfma_f32_16x16x32_bf16 v[144:147], v[60:63], a[80:83], 0
s_mul_i32 s99, s31, 20480
s_mul_i32 s23, s18, 1280
s_add_u32 s99, s99, s23
v_mfma_f32_16x16x32_bf16 v[140:143], v[64:67], a[4:7], v[140:143]
ds_read_b128 v[96:99], v2 offset:64512
s_mul_i32 s23, s19, 2621440
v_mfma_f32_16x16x32_bf16 v[144:147], v[64:67], a[84:87], v[144:147]
s_add_u32 s38, s98, 2883584
buffer_load_dwordx4 a[192:195], v1, s[4:7], s38 offen offset:0
s_waitcnt lgkmcnt(6)
v_mfma_f32_16x16x32_bf16 v[140:143], v[68:71], a[8:11], v[140:143]
ds_read_b128 v[60:63], v3 offset:2048
s_add_u32 s99, s99, s23
v_mfma_f32_16x16x32_bf16 v[144:147], v[68:71], a[88:91], v[144:147]
s_add_u32 s99, s99, 21626880
s_add_u32 s100, s99, 20480
v_mfma_f32_16x16x32_bf16 v[140:143], v[72:75], a[12:15], v[140:143]
ds_read_b128 v[64:67], v3 offset:5120
s_lshl_b32 s23, s16, 9
v_mfma_f32_16x16x32_bf16 v[144:147], v[72:75], a[92:95], v[144:147]
buffer_load_dwordx4 a[196:199], v1, s[4:7], s38 offen offset:1024
s_add_u32 s23, s23, 102400
s_waitcnt lgkmcnt(6)
v_mfma_f32_16x16x32_bf16 v[140:143], v[76:79], a[16:19], v[140:143]
ds_read_b128 v[68:71], v3 offset:8192
v_add_u32 v247, s23, v248
v_mfma_f32_16x16x32_bf16 v[144:147], v[76:79], a[96:99], v[144:147]
v_add_u32 v246, 102400, v248
s_add_u32 s39, s27, 4096
v_mfma_f32_16x16x32_bf16 v[140:143], v[80:83], a[20:23], v[140:143]
ds_read_b128 v[72:75], v3 offset:11264
v_mov_b32 v240, 0x358637bd
v_mfma_f32_16x16x32_bf16 v[144:147], v[80:83], a[100:103], v[144:147]
buffer_load_dwordx4 a[200:203], v1, s[4:7], s38 offen offset:2048
v_and_b32 v28, 15, v0
s_waitcnt lgkmcnt(6)
v_mfma_f32_16x16x32_bf16 v[140:143], v[84:87], a[24:27], v[140:143]
ds_read_b128 v[76:79], v3 offset:14336
v_and_b32 v29, 8, v17
v_mfma_f32_16x16x32_bf16 v[144:147], v[84:87], a[104:107], v[144:147]
v_sub_u32 v28, v28, v29
v_and_b32 v29, 1, v28
v_mfma_f32_16x16x32_bf16 v[140:143], v[88:91], a[28:31], v[140:143]
ds_read_b128 v[80:83], v3 offset:17408
v_lshlrev_b32 v29, 4, v29
v_mfma_f32_16x16x32_bf16 v[144:147], v[88:91], a[108:111], v[144:147]
buffer_load_dwordx4 a[204:207], v1, s[4:7], s38 offen offset:3072
v_mov_b32 v30, 0x3f80
s_waitcnt lgkmcnt(6)
v_mfma_f32_16x16x32_bf16 v[140:143], v[92:95], a[32:35], v[140:143]
ds_read_b128 v[84:87], v3 offset:20480
v_lshlrev_b32 v29, v29, v30
v_mfma_f32_16x16x32_bf16 v[144:147], v[92:95], a[112:115], v[144:147]
v_lshrrev_b32 v28, 1, v28
v_cmp_eq_u32 vcc, 0, v28
v_mfma_f32_16x16x32_bf16 v[140:143], v[96:99], a[36:39], v[140:143]
ds_read_b128 v[88:91], v3 offset:23552
v_cndmask_b32 v24, 0, v29, vcc
v_mfma_f32_16x16x32_bf16 v[144:147], v[96:99], a[116:119], v[144:147]
s_add_u32 s38, s98, 2887680
buffer_load_dwordx4 a[208:211], v1, s[4:7], s38 offen offset:0
s_waitcnt lgkmcnt(6)
v_mfma_f32_16x16x32_bf16 v[140:143], v[60:63], a[40:43], v[140:143]
ds_read_b128 v[92:95], v3 offset:26624
v_cmp_eq_u32 vcc, 1, v28
v_mfma_f32_16x16x32_bf16 v[144:147], v[60:63], a[120:123], v[144:147]
s_nop 0
v_cndmask_b32 v25, 0, v29, vcc
v_cmp_eq_u32 vcc, 2, v28
v_mfma_f32_16x16x32_bf16 v[140:143], v[64:67], a[44:47], v[140:143]
ds_read_b128 v[96:99], v3 offset:29696
v_cndmask_b32 v26, 0, v29, vcc
v_mfma_f32_16x16x32_bf16 v[144:147], v[64:67], a[124:127], v[144:147]
buffer_load_dwordx4 a[212:215], v1, s[4:7], s38 offen offset:1024
v_cmp_eq_u32 vcc, 3, v28
s_waitcnt lgkmcnt(6)
v_mfma_f32_16x16x32_bf16 v[140:143], v[68:71], a[48:51], v[140:143]
ds_read_b128 v[60:63], v2 offset:37888
v_cndmask_b32 v27, 0, v29, vcc
v_mfma_f32_16x16x32_bf16 v[144:147], v[68:71], a[128:131], v[144:147]
v_mfma_f32_16x16x32_bf16 v[140:143], v[72:75], a[52:55], v[140:143]
ds_read_b128 v[64:67], v2 offset:40960
v_mfma_f32_16x16x32_bf16 v[144:147], v[72:75], a[132:135], v[144:147]
buffer_load_dwordx4 a[216:219], v1, s[4:7], s38 offen offset:2048
s_waitcnt lgkmcnt(6)
v_mfma_f32_16x16x32_bf16 v[140:143], v[76:79], a[56:59], v[140:143]
ds_read_b128 v[68:71], v2 offset:44032
v_mfma_f32_16x16x32_bf16 v[144:147], v[76:79], a[136:139], v[144:147]
v_mfma_f32_16x16x32_bf16 v[140:143], v[80:83], a[60:63], v[140:143]
ds_read_b128 v[72:75], v2 offset:47104
v_mfma_f32_16x16x32_bf16 v[144:147], v[80:83], a[140:143], v[144:147]
buffer_load_dwordx4 a[220:223], v1, s[4:7], s38 offen offset:3072
s_waitcnt lgkmcnt(6)
v_mfma_f32_16x16x32_bf16 v[140:143], v[84:87], a[64:67], v[140:143]
ds_read_b128 v[76:79], v2 offset:50176
v_mfma_f32_16x16x32_bf16 v[144:147], v[84:87], a[144:147], v[144:147]
v_mfma_f32_16x16x32_bf16 v[140:143], v[88:91], a[68:71], v[140:143]
ds_read_b128 v[80:83], v2 offset:53248
v_mfma_f32_16x16x32_bf16 v[144:147], v[88:91], a[148:151], v[144:147]
s_add_u32 s38, s98, 2891776
buffer_load_dwordx4 a[224:227], v1, s[4:7], s38 offen offset:0
s_waitcnt lgkmcnt(6)
v_mfma_f32_16x16x32_bf16 v[140:143], v[92:95], a[72:75], v[140:143]
ds_read_b128 v[84:87], v2 offset:56320
v_mfma_f32_16x16x32_bf16 v[144:147], v[92:95], a[152:155], v[144:147]
v_mfma_f32_16x16x32_bf16 v[140:143], v[96:99], a[76:79], v[140:143]
ds_read_b128 v[88:91], v2 offset:59392
v_mfma_f32_16x16x32_bf16 v[144:147], v[96:99], a[156:159], v[144:147]
s_waitcnt vmcnt(12)
v_mfma_f32_16x16x32_bf16 v[140:143], a[180:183], v[32:35], v[140:143]
v_mfma_f32_16x16x32_bf16 v[144:147], a[180:183], v[36:39], v[144:147]
buffer_load_dwordx4 a[228:231], v1, s[4:7], s38 offen offset:1024
s_waitcnt lgkmcnt(6)
v_mfma_f32_16x16x32_bf16 v[148:151], v[60:63], a[0:3], 0
ds_read_b128 v[92:95], v2 offset:62464
v_mfma_f32_16x16x32_bf16 v[152:155], v[60:63], a[80:83], 0
v_mfma_f32_16x16x32_bf16 v[148:151], v[64:67], a[4:7], v[148:151]
ds_read_b128 v[96:99], v3 offset:0
v_mfma_f32_16x16x32_bf16 v[152:155], v[64:67], a[84:87], v[152:155]
buffer_load_dwordx4 a[232:235], v1, s[4:7], s38 offen offset:2048
v_mul_f32 v236, v140, v42
v_mul_f32 v237, v141, v42
s_waitcnt lgkmcnt(6)
v_mfma_f32_16x16x32_bf16 v[148:151], v[68:71], a[8:11], v[148:151]
ds_read_b128 v[60:63], v3 offset:3072
v_lshlrev_b32 v23, 12, v0
s_lshl_b32 s22, s18, 8
s_add_u32 s22, s22, s30
v_cndmask_b32 v23, v22, v23, s[40:41]
s_waitcnt vmcnt(11)
s_barrier
s_cmp_eq_u32 s16, 0
s_cbranch_scc0 L_if24
buffer_atomic_add v21, v23, s[4:7], s22 offen offset:128 sc1
L_if24:
v_mfma_f32_16x16x32_bf16 v[152:155], v[68:71], a[88:91], v[152:155]
v_mfma_f32_16x16x32_bf16 v[148:151], v[72:75], a[12:15], v[148:151]
ds_read_b128 v[64:67], v3 offset:6144
v_mfma_f32_16x16x32_bf16 v[152:155], v[72:75], a[92:95], v[152:155]
buffer_load_dwordx4 a[236:239], v1, s[4:7], s38 offen offset:3072
s_waitcnt lgkmcnt(6)
v_mfma_f32_16x16x32_bf16 v[148:151], v[76:79], a[16:19], v[148:151]
ds_read_b128 v[68:71], v3 offset:9216
v_mfma_f32_16x16x32_bf16 v[152:155], v[76:79], a[96:99], v[152:155]
v_mfma_f32_16x16x32_bf16 v[148:151], v[80:83], a[20:23], v[148:151]
ds_read_b128 v[72:75], v3 offset:12288
v_mul_f32 v238, v142, v42
v_mfma_f32_16x16x32_bf16 v[152:155], v[80:83], a[100:103], v[152:155]
s_add_u32 s38, s98, 2895872
buffer_load_dwordx4 a[240:243], v1, s[4:7], s38 offen offset:0
s_waitcnt lgkmcnt(6)
v_mfma_f32_16x16x32_bf16 v[148:151], v[84:87], a[24:27], v[148:151]
ds_read_b128 v[76:79], v3 offset:15360
v_mul_f32 v239, v143, v42
v_mfma_f32_16x16x32_bf16 v[152:155], v[84:87], a[104:107], v[152:155]
v_fmaak_f32 v140, v140, v40, 0x358637bd
v_fmaak_f32 v141, v141, v40, 0x358637bd
v_mfma_f32_16x16x32_bf16 v[148:151], v[88:91], a[28:31], v[148:151]
ds_read_b128 v[80:83], v3 offset:18432
v_fmaak_f32 v142, v142, v40, 0x358637bd
v_mfma_f32_16x16x32_bf16 v[152:155], v[88:91], a[108:111], v[152:155]
buffer_load_dwordx4 a[244:247], v1, s[4:7], s38 offen offset:1024
v_fmaak_f32 v143, v143, v40, 0x358637bd
s_waitcnt lgkmcnt(6)
v_mfma_f32_16x16x32_bf16 v[148:151], v[92:95], a[32:35], v[148:151]
ds_read_b128 v[84:87], v3 offset:21504
v_mfma_f32_16x16x32_bf16 v[152:155], v[92:95], a[112:115], v[152:155]
v_exp_f32 v236, v236 clamp
v_mfma_f32_16x16x32_bf16 v[148:151], v[96:99], a[36:39], v[148:151]
ds_read_b128 v[88:91], v3 offset:24576
v_exp_f32 v237, v237 clamp
v_mfma_f32_16x16x32_bf16 v[152:155], v[96:99], a[116:119], v[152:155]
buffer_load_dwordx4 a[248:251], v1, s[4:7], s38 offen offset:2048
s_waitcnt lgkmcnt(6)
v_mfma_f32_16x16x32_bf16 v[148:151], v[60:63], a[40:43], v[148:151]
ds_read_b128 v[92:95], v3 offset:27648
v_exp_f32 v238, v238 clamp
v_mfma_f32_16x16x32_bf16 v[152:155], v[60:63], a[120:123], v[152:155]
v_exp_f32 v239, v239 clamp
v_mfma_f32_16x16x32_bf16 v[148:151], v[64:67], a[44:47], v[148:151]
ds_read_b128 v[96:99], v3 offset:30720
v_max_f32 v140, 0x358637bd, v140
v_mfma_f32_16x16x32_bf16 v[152:155], v[64:67], a[124:127], v[152:155]
buffer_load_dwordx4 a[252:255], v1, s[4:7], s38 offen offset:3072
v_max_f32 v141, 0x358637bd, v141
s_waitcnt lgkmcnt(6)
v_mfma_f32_16x16x32_bf16 v[148:151], v[68:71], a[48:51], v[148:151]
ds_read_b128 v[60:63], v2 offset:38912
v_max_f32 v142, 0x358637bd, v142
v_mfma_f32_16x16x32_bf16 v[152:155], v[68:71], a[128:131], v[152:155]
v_max_f32 v143, 0x358637bd, v143
v_add_f32 v140, v140, v236
v_mfma_f32_16x16x32_bf16 v[148:151], v[72:75], a[52:55], v[148:151]
ds_read_b128 v[64:67], v2 offset:41984
v_add_f32 v141, v141, v237
v_mfma_f32_16x16x32_bf16 v[152:155], v[72:75], a[132:135], v[152:155]
s_add_u32 s38, s98, 2899968
buffer_load_dwordx4 v[164:167], v1, s[4:7], s38 offen offset:0
s_waitcnt lgkmcnt(6)
v_mfma_f32_16x16x32_bf16 v[148:151], v[76:79], a[56:59], v[148:151]
ds_read_b128 v[68:71], v2 offset:45056
v_add_f32 v142, v142, v238
v_mfma_f32_16x16x32_bf16 v[152:155], v[76:79], a[136:139], v[152:155]
v_add_f32 v143, v143, v239
v_cvt_pk_bf16_f32 v220, v140, v141
v_mfma_f32_16x16x32_bf16 v[148:151], v[80:83], a[60:63], v[148:151]
ds_read_b128 v[72:75], v2 offset:48128
v_cvt_pk_bf16_f32 v221, v142, v143
v_mfma_f32_16x16x32_bf16 v[152:155], v[80:83], a[140:143], v[152:155]
buffer_load_dwordx4 v[168:171], v1, s[4:7], s38 offen offset:1024
v_mul_f32 v236, v144, v43
s_waitcnt lgkmcnt(6)
v_mfma_f32_16x16x32_bf16 v[148:151], v[84:87], a[64:67], v[148:151]
ds_read_b128 v[76:79], v2 offset:51200
v_mul_f32 v237, v145, v43
v_mfma_f32_16x16x32_bf16 v[152:155], v[84:87], a[144:147], v[152:155]
v_mul_f32 v238, v146, v43
v_mul_f32 v239, v147, v43
v_mfma_f32_16x16x32_bf16 v[148:151], v[88:91], a[68:71], v[148:151]
ds_read_b128 v[80:83], v2 offset:54272
v_fmaak_f32 v144, v144, v41, 0x358637bd
v_mfma_f32_16x16x32_bf16 v[152:155], v[88:91], a[148:151], v[152:155]
buffer_load_dwordx4 v[172:175], v1, s[4:7], s38 offen offset:2048
v_fmaak_f32 v145, v145, v41, 0x358637bd
s_waitcnt lgkmcnt(6)
v_mfma_f32_16x16x32_bf16 v[148:151], v[92:95], a[72:75], v[148:151]
ds_read_b128 v[84:87], v2 offset:57344
v_fmaak_f32 v146, v146, v41, 0x358637bd
v_mfma_f32_16x16x32_bf16 v[152:155], v[92:95], a[152:155], v[152:155]
v_fmaak_f32 v147, v147, v41, 0x358637bd
v_mfma_f32_16x16x32_bf16 v[148:151], v[96:99], a[76:79], v[148:151]
ds_read_b128 v[88:91], v2 offset:60416
v_exp_f32 v236, v236 clamp
v_mfma_f32_16x16x32_bf16 v[152:155], v[96:99], a[156:159], v[152:155]
v_mfma_f32_16x16x32_bf16 v[148:151], a[184:187], v[32:35], v[148:151]
v_mfma_f32_16x16x32_bf16 v[152:155], a[184:187], v[36:39], v[152:155]
buffer_load_dwordx4 v[176:179], v1, s[4:7], s38 offen offset:3072
s_waitcnt lgkmcnt(6)
v_mfma_f32_16x16x32_bf16 v[156:159], v[60:63], a[0:3], 0
ds_read_b128 v[92:95], v2 offset:63488
v_mfma_f32_16x16x32_bf16 v[160:163], v[60:63], a[80:83], 0
v_mfma_f32_16x16x32_bf16 v[156:159], v[64:67], a[4:7], v[156:159]
ds_read_b128 v[96:99], v3 offset:1024
v_mfma_f32_16x16x32_bf16 v[160:163], v[64:67], a[84:87], v[160:163]
s_add_u32 s38, s98, 2904064
buffer_load_dwordx4 v[180:183], v1, s[4:7], s38 offen offset:0
s_waitcnt lgkmcnt(6)
v_mfma_f32_16x16x32_bf16 v[156:159], v[68:71], a[8:11], v[156:159]
ds_read_b128 v[60:63], v3 offset:4096
v_exp_f32 v237, v237 clamp
v_mfma_f32_16x16x32_bf16 v[160:163], v[68:71], a[88:91], v[160:163]
v_exp_f32 v238, v238 clamp
v_mfma_f32_16x16x32_bf16 v[156:159], v[72:75], a[12:15], v[156:159]
ds_read_b128 v[64:67], v3 offset:7168
v_mfma_f32_16x16x32_bf16 v[160:163], v[72:75], a[92:95], v[160:163]
buffer_load_dwordx4 v[184:187], v1, s[4:7], s38 offen offset:1024
v_exp_f32 v239, v239 clamp
s_waitcnt lgkmcnt(6)
v_mfma_f32_16x16x32_bf16 v[156:159], v[76:79], a[16:19], v[156:159]
ds_read_b128 v[68:71], v3 offset:10240
v_max_f32 v144, 0x358637bd, v144
v_mfma_f32_16x16x32_bf16 v[160:163], v[76:79], a[96:99], v[160:163]
v_max_f32 v145, 0x358637bd, v145
v_max_f32 v146, 0x358637bd, v146
v_mfma_f32_16x16x32_bf16 v[156:159], v[80:83], a[20:23], v[156:159]
ds_read_b128 v[72:75], v3 offset:13312
v_max_f32 v147, 0x358637bd, v147
v_mfma_f32_16x16x32_bf16 v[160:163], v[80:83], a[100:103], v[160:163]
buffer_load_dwordx4 v[188:191], v1, s[4:7], s38 offen offset:2048
v_add_f32 v144, v144, v236
s_waitcnt lgkmcnt(6)
v_mfma_f32_16x16x32_bf16 v[156:159], v[84:87], a[24:27], v[156:159]
ds_read_b128 v[76:79], v3 offset:16384
v_add_f32 v145, v145, v237
v_mfma_f32_16x16x32_bf16 v[160:163], v[84:87], a[104:107], v[160:163]
v_add_f32 v146, v146, v238
v_add_f32 v147, v147, v239
v_mfma_f32_16x16x32_bf16 v[156:159], v[88:91], a[28:31], v[156:159]
ds_read_b128 v[80:83], v3 offset:19456
v_mfma_f32_16x16x32_bf16 v[160:163], v[88:91], a[108:111], v[160:163]
buffer_load_dwordx4 v[192:195], v1, s[4:7], s38 offen offset:3072
v_cvt_pk_bf16_f32 v228, v144, v145
s_waitcnt lgkmcnt(6)
v_mfma_f32_16x16x32_bf16 v[156:159], v[92:95], a[32:35], v[156:159]
ds_read_b128 v[84:87], v3 offset:22528
s_cmp_eq_u32 s16, 0
s_cbranch_scc0 L_if25
s_lshl_b32 s101, s17, 4
s_add_u32 s101, s101, s18
s_lshl_b32 s101, s101, 8
s_add_u32 s101, s101, s30
v_mov_b32 v23, 0
buffer_atomic_add v23, v22, s[4:7], s101 offen offset:128 sc0 sc1
L_if25:
v_mfma_f32_16x16x32_bf16 v[160:163], v[92:95], a[112:115], v[160:163]
v_cvt_pk_bf16_f32 v229, v146, v147
v_mfma_f32_16x16x32_bf16 v[156:159], v[96:99], a[36:39], v[156:159]
ds_read_b128 v[88:91], v3 offset:25600
v_mul_f32 v236, v148, v42
v_mfma_f32_16x16x32_bf16 v[160:163], v[96:99], a[116:119], v[160:163]
s_add_u32 s38, s98, 2908160
buffer_load_dwordx4 v[196:199], v1, s[4:7], s38 offen offset:0
s_waitcnt lgkmcnt(6)
v_mfma_f32_16x16x32_bf16 v[156:159], v[60:63], a[40:43], v[156:159]
ds_read_b128 v[92:95], v3 offset:28672
v_mul_f32 v237, v149, v42
v_mfma_f32_16x16x32_bf16 v[160:163], v[60:63], a[120:123], v[160:163]
v_mul_f32 v238, v150, v42
v_mul_f32 v239, v151, v42
v_mfma_f32_16x16x32_bf16 v[156:159], v[64:67], a[44:47], v[156:159]
ds_read_b128 v[96:99], v3 offset:31744
v_fmaak_f32 v148, v148, v40, 0x358637bd
v_mfma_f32_16x16x32_bf16 v[160:163], v[64:67], a[124:127], v[160:163]
s_add_u32 s96, s36, 3702784
s_add_u32 m0, s37, 0
s_nop 0
buffer_load_dwordx4 v1, s[4:7], s96 offen offset:0 lds
s_waitcnt lgkmcnt(6)
v_mfma_f32_16x16x32_bf16 v[156:159], v[68:71], a[48:51], v[156:159]
v_fmaak_f32 v149, v149, v40, 0x358637bd
v_mfma_f32_16x16x32_bf16 v[160:163], v[68:71], a[128:131], v[160:163]
v_fmaak_f32 v150, v150, v40, 0x358637bd
v_fmaak_f32 v151, v151, v40, 0x358637bd
v_mfma_f32_16x16x32_bf16 v[156:159], v[72:75], a[52:55], v[156:159]
v_exp_f32 v236, v236 clamp
v_mfma_f32_16x16x32_bf16 v[160:163], v[72:75], a[132:135], v[160:163]
buffer_load_dwordx4 v1, s[4:7], s96 offen offset:1024 lds
s_waitcnt lgkmcnt(4)
v_mfma_f32_16x16x32_bf16 v[156:159], v[76:79], a[56:59], v[156:159]
v_exp_f32 v237, v237 clamp
v_mfma_f32_16x16x32_bf16 v[160:163], v[76:79], a[136:139], v[160:163]
v_exp_f32 v238, v238 clamp
v_mfma_f32_16x16x32_bf16 v[156:159], v[80:83], a[60:63], v[156:159]
v_exp_f32 v239, v239 clamp
v_max_f32 v148, 0x358637bd, v148
v_mfma_f32_16x16x32_bf16 v[160:163], v[80:83], a[140:143], v[160:163]
buffer_load_dwordx4 v1, s[4:7], s96 offen offset:2048 lds
v_max_f32 v149, 0x358637bd, v149
s_waitcnt lgkmcnt(2)
v_mfma_f32_16x16x32_bf16 v[156:159], v[84:87], a[64:67], v[156:159]
v_max_f32 v150, 0x358637bd, v150
v_max_f32 v151, 0x358637bd, v151
v_mfma_f32_16x16x32_bf16 v[160:163], v[84:87], a[144:147], v[160:163]
v_add_f32 v148, v148, v236
v_add_f32 v149, v149, v237
v_mfma_f32_16x16x32_bf16 v[156:159], v[88:91], a[68:71], v[156:159]
v_add_f32 v150, v150, v238
v_add_f32 v151, v151, v239
v_mfma_f32_16x16x32_bf16 v[160:163], v[88:91], a[148:151], v[160:163]
buffer_load_dwordx4 v1, s[4:7], s96 offen offset:3072 lds
v_cvt_pk_bf16_f32 v224, v148, v149
s_waitcnt lgkmcnt(0)
v_mfma_f32_16x16x32_bf16 v[156:159], v[92:95], a[72:75], v[156:159]
v_cvt_pk_bf16_f32 v225, v150, v151
v_mul_f32 v236, v152, v43
v_mfma_f32_16x16x32_bf16 v[160:163], v[92:95], a[152:155], v[160:163]
v_mul_f32 v237, v153, v43
v_mul_f32 v238, v154, v43
v_mfma_f32_16x16x32_bf16 v[156:159], v[96:99], a[76:79], v[156:159]
v_mul_f32 v239, v155, v43
v_fmaak_f32 v152, v152, v41, 0x358637bd
v_mfma_f32_16x16x32_bf16 v[160:163], v[96:99], a[156:159], v[160:163]
s_add_u32 s96, s36, 3706880
s_add_u32 m0, s37, 4096
s_nop 0
buffer_load_dwordx4 v1, s[4:7], s96 offen offset:0 lds
v_mfma_f32_16x16x32_bf16 v[156:159], a[188:191], v[32:35], v[156:159]
v_mfma_f32_16x16x32_bf16 v[160:163], a[188:191], v[36:39], v[160:163]
v_fmaak_f32 v153, v153, v41, 0x358637bd
v_fmaak_f32 v154, v154, v41, 0x358637bd
v_fmaak_f32 v155, v155, v41, 0x358637bd
v_exp_f32 v236, v236 clamp
v_exp_f32 v237, v237 clamp
v_exp_f32 v238, v238 clamp
v_exp_f32 v239, v239 clamp
v_max_f32 v152, 0x358637bd, v152
v_max_f32 v153, 0x358637bd, v153
v_max_f32 v154, 0x358637bd, v154
v_max_f32 v155, 0x358637bd, v155
v_add_f32 v152, v152, v236
v_add_f32 v153, v153, v237
buffer_load_dwordx4 v1, s[4:7], s96 offen offset:1024 lds
v_add_f32 v154, v154, v238
v_add_f32 v155, v155, v239
v_cvt_pk_bf16_f32 v232, v152, v153
v_cvt_pk_bf16_f32 v233, v154, v155
v_pk_mul_f32 v[236:237], v[156:157], v[42:43] op_sel:[0,0] op_sel_hi:[1,0]
v_pk_mul_f32 v[238:239], v[158:159], v[42:43] op_sel:[0,0] op_sel_hi:[1,0]
v_pk_fma_f32 v[156:157], v[156:157], v[40:41], v[240:241] op_sel:[0,0,0] op_sel_hi:[1,0,0]
v_pk_fma_f32 v[158:159], v[158:159], v[40:41], v[240:241] op_sel:[0,0,0] op_sel_hi:[1,0,0]
v_exp_f32 v236, v236 clamp
v_exp_f32 v237, v237 clamp
v_exp_f32 v238, v238 clamp
v_exp_f32 v239, v239 clamp
buffer_load_dwordx4 v1, s[4:7], s96 offen offset:2048 lds
v_max_f32 v156, 0x358637bd, v156
v_max_f32 v157, 0x358637bd, v157
v_max_f32 v158, 0x358637bd, v158
v_max_f32 v159, 0x358637bd, v159
v_pk_add_f32 v[156:157], v[156:157], v[236:237]
v_pk_add_f32 v[158:159], v[158:159], v[238:239]
v_cvt_pk_bf16_f32 v222, v156, v157
v_cvt_pk_bf16_f32 v223, v158, v159
v_cvt_pk_bf16_f32 v226, v156, v157
v_cvt_pk_bf16_f32 v227, v158, v159
v_pk_mul_f32 v[236:237], v[160:161], v[42:43] op_sel:[0,1] op_sel_hi:[1,1]
v_pk_mul_f32 v[238:239], v[162:163], v[42:43] op_sel:[0,1] op_sel_hi:[1,1]
v_pk_fma_f32 v[160:161], v[160:161], v[40:41], v[240:241] op_sel:[0,1,0] op_sel_hi:[1,1,0]
v_pk_fma_f32 v[162:163], v[162:163], v[40:41], v[240:241] op_sel:[0,1,0] op_sel_hi:[1,1,0]
v_exp_f32 v236, v236 clamp
v_exp_f32 v237, v237 clamp
v_exp_f32 v238, v238 clamp
v_exp_f32 v239, v239 clamp
v_max_f32 v160, 0x358637bd, v160
v_max_f32 v161, 0x358637bd, v161
v_max_f32 v162, 0x358637bd, v162
v_max_f32 v163, 0x358637bd, v163
v_pk_add_f32 v[160:161], v[160:161], v[236:237]
v_pk_add_f32 v[162:163], v[162:163], v[238:239]
v_cvt_pk_bf16_f32 v230, v160, v161
v_cvt_pk_bf16_f32 v231, v162, v163
v_cvt_pk_bf16_f32 v234, v160, v161
v_cvt_pk_bf16_f32 v235, v162, v163
s_mul_i32 s98, s18, 286720
s_cmp_eq_u32 s16, 0
s_cbranch_scc0 L_if26
s_waitcnt vmcnt(8)
v_readfirstlane_b32 s23, v23
s_mov_b32 s33, 0
s_cmp_ge_u32 s23, 16
s_cbranch_scc1 L_polld2
L_poll2:
v_mov_b32 v23, 0
buffer_atomic_add v23, v22, s[4:7], s101 offen offset:128 sc0 sc1
s_waitcnt vmcnt(0)
v_readfirstlane_b32 s23, v23
s_add_u32 s33, s33, 1
s_cmp_ge_u32 s23, 16
s_cbranch_scc1 L_polld2
s_cmp_lt_u32 s33, 400000
s_cbranch_scc1 L_poll2
L_polld2:
L_if26:
s_barrier
buffer_load_dwordx4 v[60:63], v1, s[4:7], s27 offen offset:0 sc1
buffer_load_dwordx4 v[64:67], v1, s[4:7], s27 offen offset:1024 sc1
buffer_load_dwordx4 v[68:71], v1, s[4:7], s27 offen offset:2048 sc1
buffer_load_dwordx4 v[72:75], v1, s[4:7], s27 offen offset:3072 sc1
buffer_load_dwordx4 v[76:79], v1, s[4:7], s39 offen offset:0 sc1
buffer_load_dwordx4 v[80:83], v1, s[4:7], s39 offen offset:1024 sc1
buffer_load_dwordx4 v[84:87], v1, s[4:7], s39 offen offset:2048 sc1
buffer_load_dwordx4 v[88:91], v1, s[4:7], s39 offen offset:3072 sc1
s_waitcnt vmcnt(7)
v_mfma_f32_16x16x32_bf16 v[28:31], v[24:27], v[60:63], 0
s_waitcnt vmcnt(6)
v_mfma_f32_16x16x32_bf16 v[28:31], v[24:27], v[64:67], v[28:31]
s_waitcnt vmcnt(5)
v_mfma_f32_16x16x32_bf16 v[28:31], v[24:27], v[68:71], v[28:31]
s_waitcnt vmcnt(4)
v_mfma_f32_16x16x32_bf16 v[28:31], v[24:27], v[72:75], v[28:31]
s_waitcnt vmcnt(3)
v_mfma_f32_16x16x32_bf16 v[28:31], v[24:27], v[76:79], v[28:31]
s_waitcnt vmcnt(2)
v_mfma_f32_16x16x32_bf16 v[28:31], v[24:27], v[80:83], v[28:31]
s_waitcnt vmcnt(1)
v_mfma_f32_16x16x32_bf16 v[28:31], v[24:27], v[84:87], v[28:31]
s_waitcnt vmcnt(0)
v_mfma_f32_16x16x32_bf16 v[28:31], v[24:27], v[88:91], v[28:31]
s_nop 7
v_cvt_pk_bf16_f32 v28, v28, v29
v_cvt_pk_bf16_f32 v29, v30, v31
ds_write_b64 v247, v[28:29]
s_add_u32 s38, s12, 8290304
buffer_load_dwordx4 a[160:163], v1, s[4:7], s38 offen offset:0 sc1
buffer_load_dwordx4 a[164:167], v1, s[4:7], s38 offen offset:1024 sc1
buffer_load_dwordx4 a[168:171], v1, s[4:7], s38 offen offset:2048 sc1
s_waitcnt lgkmcnt(0)
s_barrier
ds_read_b64 v[240:241], v246 offset:1536
ds_read_b64 v[238:239], v246 offset:1024
ds_read_b64 v[80:81], v246 offset:0
ds_read_b64 v[84:85], v246 offset:512
s_waitcnt lgkmcnt(3)
v_cndmask_b32 v82, 0, v240, s[40:41]
v_cndmask_b32 v86, 0, v240, s[42:43]
s_waitcnt lgkmcnt(2)
v_cndmask_b32 v88, 0, v238, s[52:53]
v_cndmask_b32 v90, 0, v240, s[48:49]
v_cndmask_b32 v92, 0, v238, s[46:47]
v_cndmask_b32 v94, 0, v240, s[50:51]
v_cndmask_b32 v83, 0, v241, s[40:41]
v_cndmask_b32 v87, 0, v241, s[42:43]
v_cndmask_b32 v89, 0, v239, s[52:53]
buffer_load_dwordx4 a[172:175], v1, s[4:7], s38 offen offset:3072 sc1
v_cndmask_b32 v91, 0, v241, s[48:49]
v_cndmask_b32 v93, 0, v239, s[46:47]
v_cndmask_b32 v95, 0, v241, s[50:51]
v_mfma_f32_16x16x32_bf16 v[108:111], v[88:91], v[220:223], 0
v_mfma_f32_16x16x32_bf16 v[120:123], v[88:91], v[228:231], 0
v_mfma_f32_16x16x32_bf16 v[108:111], v[92:95], v[224:227], v[108:111]
v_mfma_f32_16x16x32_bf16 v[120:123], v[92:95], v[232:235], v[120:123]
s_waitcnt lgkmcnt(1)
v_mfma_f32_16x16x32_bf16 v[100:103], v[80:83], v[220:223], 0
s_waitcnt lgkmcnt(0)
v_mfma_f32_16x16x32_bf16 v[104:107], v[84:87], v[224:227], 0
v_mfma_f32_16x16x32_bf16 v[112:115], v[80:83], v[228:231], 0
v_mfma_f32_16x16x32_bf16 v[116:119], v[84:87], v[232:235], 0
s_nop 2
v_add_f32 v236, 0x358637bd, v108
s_add_u32 s38, s13, 8294400
buffer_load_dwordx4 a[176:179], v1, s[4:7], s38 offen offset:0 sc1
v_add_f32 v238, 0x358637bd, v120
v_rcp_f32 v236, v236
v_rcp_f32 v238, v238
v_mov_b32 v237, v236
v_mov_b32 v239, v238
s_nop 0
v_permlane32_swap_b32 v236, v237
v_permlane32_swap_b32 v238, v239
v_mul_f32 v108, v108, v236
v_mul_f32 v120, v120, v238
v_mul_f32 v109, v109, v236
v_mul_f32 v121, v121, v238
v_mul_f32 v110, v110, v236
v_mul_f32 v122, v122, v238
buffer_load_dwordx4 a[180:183], v1, s[4:7], s38 offen offset:1024 sc1
v_mul_f32 v111, v111, v236
v_mul_f32 v123, v123, v238
v_mov_b32 v237, v236
v_mov_b32 v239, v238
s_nop 0
v_permlane16_swap_b32 v236, v237
v_permlane16_swap_b32 v238, v239
v_mul_f32 v100, v100, v236
v_mul_f32 v112, v112, v238
v_mul_f32 v104, v104, v237
v_mul_f32 v116, v116, v239
v_mul_f32 v101, v101, v236
v_mul_f32 v113, v113, v238
buffer_load_dwordx4 a[184:187], v1, s[4:7], s38 offen offset:2048 sc1
v_mul_f32 v105, v105, v237
v_mul_f32 v117, v117, v239
v_mul_f32 v102, v102, v236
v_mul_f32 v114, v114, v238
v_mul_f32 v106, v106, v237
v_mul_f32 v118, v118, v239
v_mul_f32 v103, v103, v236
v_mul_f32 v115, v115, v238
v_mul_f32 v107, v107, v237
v_mul_f32 v119, v119, v239
v_cvt_pk_bf16_f32 v124, v100, v101
v_cvt_pk_bf16_f32 v132, v112, v113
v_cvt_pk_bf16_f32 v125, v102, v103
v_cvt_pk_bf16_f32 v133, v114, v115
v_cvt_pk_bf16_f32 v126, v104, v105
v_cvt_pk_bf16_f32 v134, v116, v117
v_cvt_pk_bf16_f32 v127, v106, v107
v_cvt_pk_bf16_f32 v135, v118, v119
v_cvt_pk_bf16_f32 v128, v108, v109
v_cvt_pk_bf16_f32 v136, v120, v121
v_cvt_pk_bf16_f32 v129, v110, v111
v_cvt_pk_bf16_f32 v137, v122, v123
buffer_store_dwordx4 v[124:127], v1, s[4:7], s99 offen sc1
buffer_store_dwordx2 v[128:129], v18, s[4:7], s99 offen offset:1024 sc1
buffer_store_dwordx4 v[132:135], v1, s[4:7], s100 offen sc1
buffer_store_dwordx2 v[136:137], v18, s[4:7], s100 offen offset:1024 sc1
v_lshlrev_b32 v23, 8, v0
s_lshl_b32 s22, s17, 12
s_add_u32 s22, s22, s30
v_cndmask_b32 v23, v22, v23, s[40:41]
s_waitcnt vmcnt(0)
s_barrier
s_cmp_eq_u32 s16, 0
s_cbranch_scc0 L_if27
buffer_atomic_add v21, v23, s[4:7], s22 offen offset:4 sc1
L_if27:
s_cmp_eq_u32 s16, 0
s_cbranch_scc1 L_if28
s_mul_i32 s24, s16, 24576
s_add_u32 s25, s98, s24
s_add_u32 s26, s25, 3706880
s_add_u32 m0, s24, 4096
s_nop 0
buffer_load_dwordx4 v1, s[4:7], s26 offen offset:0 lds
buffer_load_dwordx4 v1, s[4:7], s26 offen offset:1024 lds
buffer_load_dwordx4 v1, s[4:7], s26 offen offset:2048 lds
buffer_load_dwordx4 v1, s[4:7], s26 offen offset:3072 lds
s_add_u32 s26, s25, 3710976
s_add_u32 m0, s24, 8192
s_nop 0
buffer_load_dwordx4 v1, s[4:7], s26 offen offset:0 lds
buffer_load_dwordx4 v1, s[4:7], s26 offen offset:1024 lds
buffer_load_dwordx4 v1, s[4:7], s26 offen offset:2048 lds
buffer_load_dwordx4 v1, s[4:7], s26 offen offset:3072 lds
s_add_u32 s26, s25, 3715072
s_add_u32 m0, s24, 12288
s_nop 0
buffer_load_dwordx4 v1, s[4:7], s26 offen offset:0 lds
buffer_load_dwordx4 v1, s[4:7], s26 offen offset:1024 lds
buffer_load_dwordx4 v1, s[4:7], s26 offen offset:2048 lds
buffer_load_dwordx4 v1, s[4:7], s26 offen offset:3072 lds
s_add_u32 s26, s25, 3719168
s_add_u32 m0, s24, 16384
s_nop 0
buffer_load_dwordx4 v1, s[4:7], s26 offen offset:0 lds
buffer_load_dwordx4 v1, s[4:7], s26 offen offset:1024 lds
buffer_load_dwordx4 v1, s[4:7], s26 offen offset:2048 lds
buffer_load_dwordx4 v1, s[4:7], s26 offen offset:3072 lds
s_add_u32 s26, s25, 3723264
s_add_u32 m0, s24, 20480
s_nop 0
buffer_load_dwordx4 v1, s[4:7], s26 offen offset:0 lds
buffer_load_dwordx4 v1, s[4:7], s26 offen offset:1024 lds
buffer_load_dwordx4 v1, s[4:7], s26 offen offset:2048 lds
buffer_load_dwordx4 v1, s[4:7], s26 offen offset:3072 lds
s_add_u32 s26, s25, 3727360
s_add_u32 m0, s24, 24576
s_nop 0
buffer_load_dwordx4 v1, s[4:7], s26 offen offset:0 lds
buffer_load_dwordx4 v1, s[4:7], s26 offen offset:1024 lds
buffer_load_dwordx4 v1, s[4:7], s26 offen offset:2048 lds
buffer_load_dwordx4 v1, s[4:7], s26 offen offset:3072 lds
L_if28:
s_sub_u32 s100, s32, s16
s_mul_i32 s100, s100, 20480
s_add_u32 s100, s100, 21626880
s_mul_i32 s34, s16, 5120
s_add_u32 s100, s100, s34
s_mul_i32 s34, s19, 2621440
s_add_u32 s100, s100, s34
s_add_u32 s34, s16, 0
s_and_b32 s34, s34, 3
s_mul_i32 s34, s34, 20480
s_add_u32 s34, s34, s100
s_add_u32 s35, s16, 1
s_and_b32 s35, s35, 3
s_mul_i32 s35, s35, 20480
s_add_u32 s35, s35, s100
s_add_u32 s36, s16, 2
s_and_b32 s36, s36, 3
s_mul_i32 s36, s36, 20480
s_add_u32 s36, s36, s100
s_add_u32 s37, s16, 3
s_and_b32 s37, s37, 3
s_mul_i32 s37, s37, 20480
s_add_u32 s37, s37, s100
s_add_u32 s23, s16, 0
s_and_b32 s23, s23, 3
s_mul_i32 s25, s23, 15360
s_add_u32 s25, s25, 102400
v_add_u32 v144, s25, v1
s_add_u32 s23, s16, 1
s_and_b32 s23, s23, 3
s_mul_i32 s25, s23, 15360
s_add_u32 s25, s25, 102400
v_add_u32 v145, s25, v1
s_add_u32 s23, s16, 2
s_and_b32 s23, s23, 3
s_mul_i32 s25, s23, 15360
s_add_u32 s25, s25, 102400
v_add_u32 v146, s25, v1
s_add_u32 s23, s16, 3
s_and_b32 s23, s23, 3
s_mul_i32 s25, s23, 15360
s_add_u32 s25, s25, 102400
v_add_u32 v147, s25, v1
v_lshlrev_b32 v24, 16, v4
v_and_b32 v25, 0xffff0000, v4
v_lshlrev_b32 v26, 16, v5
v_and_b32 v27, 0xffff0000, v5
v_lshlrev_b32 v28, 16, v6
v_and_b32 v29, 0xffff0000, v6
v_lshlrev_b32 v30, 16, v7
v_and_b32 v31, 0xffff0000, v7
v_lshlrev_b32 v32, 16, v8
v_and_b32 v33, 0xffff0000, v8
v_lshlrev_b32 v34, 16, v9
v_and_b32 v35, 0xffff0000, v9
v_lshlrev_b32 v36, 16, v10
v_and_b32 v37, 0xffff0000, v10
v_lshlrev_b32 v38, 16, v11
v_and_b32 v39, 0xffff0000, v11
v_lshlrev_b32 v40, 16, v12
v_and_b32 v41, 0xffff0000, v12
v_lshlrev_b32 v42, 16, v13
v_and_b32 v43, 0xffff0000, v13
s_cmp_eq_u32 s16, 0
s_cbranch_scc0 L_if29
s_lshl_b32 s101, s17, 4
s_add_u32 s101, s101, s18
s_lshl_b32 s101, s101, 8
s_add_u32 s101, s101, s30
v_mov_b32 v23, 0
buffer_atomic_add v23, v22, s[4:7], s101 offen offset:4 sc0 sc1
L_if29:
s_cmp_eq_u32 s16, 0
s_cbranch_scc0 L_if30
s_waitcnt vmcnt(0)
v_readfirstlane_b32 s23, v23
s_mov_b32 s33, 0
s_cmp_ge_u32 s23, 16
s_cbranch_scc1 L_polld3
L_poll3:
v_mov_b32 v23, 0
buffer_atomic_add v23, v22, s[4:7], s101 offen offset:4 sc0 sc1
s_waitcnt vmcnt(0)
v_readfirstlane_b32 s23, v23
s_add_u32 s33, s33, 1
s_cmp_ge_u32 s23, 16
s_cbranch_scc1 L_polld3
s_cmp_lt_u32 s33, 400000
s_cbranch_scc1 L_poll3
L_polld3:
L_if30:
s_barrier
buffer_load_dwordx4 a[0:3], v1, s[4:7], s34 offen offset:0 sc1
buffer_load_dwordx4 a[4:7], v1, s[4:7], s35 offen offset:0 sc1
buffer_load_dwordx4 a[8:11], v1, s[4:7], s36 offen offset:0 sc1
buffer_load_dwordx4 a[12:15], v1, s[4:7], s37 offen offset:0 sc1
s_barrier
buffer_load_dwordx4 a[16:19], v1, s[4:7], s34 offen offset:1024 sc1
buffer_load_dwordx4 a[20:23], v1, s[4:7], s35 offen offset:1024 sc1
buffer_load_dwordx4 a[24:27], v1, s[4:7], s36 offen offset:1024 sc1
buffer_load_dwordx4 a[28:31], v1, s[4:7], s37 offen offset:1024 sc1
s_waitcnt vmcnt(7)
v_mfma_f32_16x16x32_bf16 v[24:27], a[192:195], a[0:3], v[24:27]
v_mfma_f32_16x16x32_bf16 v[28:31], a[196:199], a[0:3], v[28:31]
v_mfma_f32_16x16x32_bf16 v[32:35], a[200:203], a[0:3], v[32:35]
v_mfma_f32_16x16x32_bf16 v[36:39], a[204:207], a[0:3], v[36:39]
buffer_load_dwordx4 a[32:35], v1, s[4:7], s34 offen offset:2048 sc1
v_mfma_f32_16x16x32_bf16 v[40:43], a[208:211], a[0:3], v[40:43]
s_waitcnt vmcnt(7)
v_mfma_f32_16x16x32_bf16 v[44:47], a[192:195], a[4:7], 0
v_mfma_f32_16x16x32_bf16 v[48:51], a[196:199], a[4:7], 0
v_mfma_f32_16x16x32_bf16 v[52:55], a[200:203], a[4:7], 0
buffer_load_dwordx4 a[36:39], v1, s[4:7], s35 offen offset:2048 sc1
v_mfma_f32_16x16x32_bf16 v[56:59], a[204:207], a[4:7], 0
v_mfma_f32_16x16x32_bf16 v[60:63], a[208:211], a[4:7], 0
s_waitcnt vmcnt(7)
v_mfma_f32_16x16x32_bf16 v[64:67], a[192:195], a[8:11], 0
v_mfma_f32_16x16x32_bf16 v[68:71], a[196:199], a[8:11], 0
buffer_load_dwordx4 a[40:43], v1, s[4:7], s36 offen offset:2048 sc1
v_mfma_f32_16x16x32_bf16 v[72:75], a[200:203], a[8:11], 0
v_mfma_f32_16x16x32_bf16 v[76:79], a[204:207], a[8:11], 0
v_mfma_f32_16x16x32_bf16 v[80:83], a[208:211], a[8:11], 0
s_waitcnt vmcnt(7)
v_mfma_f32_16x16x32_bf16 v[84:87], a[192:195], a[12:15], 0
buffer_load_dwordx4 a[44:47], v1, s[4:7], s37 offen offset:2048 sc1
v_mfma_f32_16x16x32_bf16 v[88:91], a[196:199], a[12:15], 0
v_mfma_f32_16x16x32_bf16 v[92:95], a[200:203], a[12:15], 0
v_mfma_f32_16x16x32_bf16 v[96:99], a[204:207], a[12:15], 0
v_mfma_f32_16x16x32_bf16 v[100:103], a[208:211], a[12:15], 0
buffer_load_dwordx4 a[52:55], v1, s[4:7], s35 offen offset:3072 sc1
s_waitcnt vmcnt(8)
v_mfma_f32_16x16x32_bf16 v[24:27], a[212:215], a[16:19], v[24:27]
v_mfma_f32_16x16x32_bf16 v[28:31], a[216:219], a[16:19], v[28:31]
v_mfma_f32_16x16x32_bf16 v[32:35], a[220:223], a[16:19], v[32:35]
v_mfma_f32_16x16x32_bf16 v[36:39], a[224:227], a[16:19], v[36:39]
s_add_u32 s35, s35, 4096
buffer_load_dwordx4 a[68:71], v1, s[4:7], s35 offen offset:0 sc1
v_mfma_f32_16x16x32_bf16 v[40:43], a[228:231], a[16:19], v[40:43]
s_waitcnt vmcnt(8)
v_mfma_f32_16x16x32_bf16 v[44:47], a[212:215], a[20:23], v[44:47]
v_mfma_f32_16x16x32_bf16 v[48:51], a[216:219], a[20:23], v[48:51]
v_mfma_f32_16x16x32_bf16 v[52:55], a[220:223], a[20:23], v[52:55]
buffer_load_dwordx4 a[56:59], v1, s[4:7], s36 offen offset:3072 sc1
v_mfma_f32_16x16x32_bf16 v[56:59], a[224:227], a[20:23], v[56:59]
v_mfma_f32_16x16x32_bf16 v[60:63], a[228:231], a[20:23], v[60:63]
s_waitcnt vmcnt(8)
v_mfma_f32_16x16x32_bf16 v[64:67], a[212:215], a[24:27], v[64:67]
v_mfma_f32_16x16x32_bf16 v[68:71], a[216:219], a[24:27], v[68:71]
s_add_u32 s36, s36, 4096
buffer_load_dwordx4 a[72:75], v1, s[4:7], s36 offen offset:0 sc1
v_mfma_f32_16x16x32_bf16 v[72:75], a[220:223], a[24:27], v[72:75]
v_mfma_f32_16x16x32_bf16 v[76:79], a[224:227], a[24:27], v[76:79]
v_mfma_f32_16x16x32_bf16 v[80:83], a[228:231], a[24:27], v[80:83]
s_waitcnt vmcnt(8)
v_mfma_f32_16x16x32_bf16 v[84:87], a[212:215], a[28:31], v[84:87]
buffer_load_dwordx4 a[60:63], v1, s[4:7], s37 offen offset:3072 sc1
v_mfma_f32_16x16x32_bf16 v[88:91], a[216:219], a[28:31], v[88:91]
v_mfma_f32_16x16x32_bf16 v[92:95], a[220:223], a[28:31], v[92:95]
v_mfma_f32_16x16x32_bf16 v[96:99], a[224:227], a[28:31], v[96:99]
v_mfma_f32_16x16x32_bf16 v[100:103], a[228:231], a[28:31], v[100:103]
s_add_u32 s37, s37, 4096
buffer_load_dwordx4 a[76:79], v1, s[4:7], s37 offen offset:0 sc1
s_waitcnt vmcnt(9)
v_mfma_f32_16x16x32_bf16 v[24:27], a[232:235], a[32:35], v[24:27]
v_mfma_f32_16x16x32_bf16 v[28:31], a[236:239], a[32:35], v[28:31]
v_mfma_f32_16x16x32_bf16 v[32:35], a[240:243], a[32:35], v[32:35]
v_mfma_f32_16x16x32_bf16 v[36:39], a[244:247], a[32:35], v[36:39]
buffer_load_dwordx4 a[48:51], v1, s[4:7], s34 offen offset:3072 sc1
s_add_u32 s38, s14, 8414208
buffer_load_dwordx4 v[200:203], v1, s[4:7], s38 offen offset:0
v_mfma_f32_16x16x32_bf16 v[40:43], a[248:251], a[32:35], v[40:43]
s_waitcnt vmcnt(10)
v_mfma_f32_16x16x32_bf16 v[44:47], a[232:235], a[36:39], v[44:47]
v_mfma_f32_16x16x32_bf16 v[48:51], a[236:239], a[36:39], v[48:51]
v_mfma_f32_16x16x32_bf16 v[52:55], a[240:243], a[36:39], v[52:55]
s_add_u32 s34, s34, 4096
buffer_load_dwordx4 a[64:67], v1, s[4:7], s34 offen offset:0 sc1
buffer_load_dwordx4 v[204:207], v1, s[4:7], s38 offen offset:1024
v_mfma_f32_16x16x32_bf16 v[56:59], a[244:247], a[36:39], v[56:59]
v_mfma_f32_16x16x32_bf16 v[60:63], a[248:251], a[36:39], v[60:63]
s_waitcnt vmcnt(11)
v_mfma_f32_16x16x32_bf16 v[64:67], a[232:235], a[40:43], v[64:67]
buffer_load_dwordx4 v[208:211], v1, s[4:7], s38 offen offset:2048
v_mfma_f32_16x16x32_bf16 v[68:71], a[236:239], a[40:43], v[68:71]
v_mfma_f32_16x16x32_bf16 v[72:75], a[240:243], a[40:43], v[72:75]
v_mfma_f32_16x16x32_bf16 v[76:79], a[244:247], a[40:43], v[76:79]
v_mfma_f32_16x16x32_bf16 v[80:83], a[248:251], a[40:43], v[80:83]
buffer_load_dwordx4 v[212:215], v1, s[4:7], s38 offen offset:3072
s_waitcnt vmcnt(12)
v_mfma_f32_16x16x32_bf16 v[84:87], a[232:235], a[44:47], v[84:87]
v_mfma_f32_16x16x32_bf16 v[88:91], a[236:239], a[44:47], v[88:91]
v_mfma_f32_16x16x32_bf16 v[92:95], a[240:243], a[44:47], v[92:95]
s_add_u32 s38, s14, 8418304
buffer_load_dwordx4 v[216:219], v1, s[4:7], s38 offen offset:0
v_mfma_f32_16x16x32_bf16 v[96:99], a[244:247], a[44:47], v[96:99]
v_mfma_f32_16x16x32_bf16 v[100:103], a[248:251], a[44:47], v[100:103]
s_waitcnt vmcnt(12)
v_mfma_f32_16x16x32_bf16 v[44:47], a[252:255], a[52:55], v[44:47]
v_mfma_f32_16x16x32_bf16 v[48:51], v[164:167], a[52:55], v[48:51]
buffer_load_dwordx4 v[220:223], v1, s[4:7], s38 offen offset:1024
v_mfma_f32_16x16x32_bf16 v[52:55], v[168:171], a[52:55], v[52:55]
v_mfma_f32_16x16x32_bf16 v[56:59], v[172:175], a[52:55], v[56:59]
v_mfma_f32_16x16x32_bf16 v[60:63], v[176:179], a[52:55], v[60:63]
buffer_load_dwordx4 v[224:227], v1, s[4:7], s38 offen offset:2048
s_waitcnt vmcnt(13)
v_mfma_f32_16x16x32_bf16 v[44:47], v[180:183], a[68:71], v[44:47]
v_mfma_f32_16x16x32_bf16 v[48:51], v[184:187], a[68:71], v[48:51]
v_mfma_f32_16x16x32_bf16 v[52:55], v[188:191], a[68:71], v[52:55]
v_mfma_f32_16x16x32_bf16 v[56:59], v[192:195], a[68:71], v[56:59]
buffer_load_dwordx4 v[228:231], v1, s[4:7], s38 offen offset:3072
v_mfma_f32_16x16x32_bf16 v[60:63], v[196:199], a[68:71], v[60:63]
s_waitcnt vmcnt(13)
v_mfma_f32_16x16x32_bf16 v[64:67], a[252:255], a[56:59], v[64:67]
s_nop 1
ds_write_b128 v145, v[44:47] offset:0
v_mfma_f32_16x16x32_bf16 v[68:71], v[164:167], a[56:59], v[68:71]
v_mfma_f32_16x16x32_bf16 v[72:75], v[168:171], a[56:59], v[72:75]
ds_write_b128 v145, v[48:51] offset:1024
s_add_u32 s38, s14, 8422400
buffer_load_dwordx4 v[232:235], v1, s[4:7], s38 offen offset:0
v_mfma_f32_16x16x32_bf16 v[76:79], v[172:175], a[56:59], v[76:79]
v_mfma_f32_16x16x32_bf16 v[80:83], v[176:179], a[56:59], v[80:83]
ds_write_b128 v145, v[52:55] offset:2048
s_waitcnt vmcnt(13)
v_mfma_f32_16x16x32_bf16 v[64:67], v[180:183], a[72:75], v[64:67]
buffer_load_dwordx4 v[236:239], v1, s[4:7], s38 offen offset:1024
v_mfma_f32_16x16x32_bf16 v[68:71], v[184:187], a[72:75], v[68:71]
ds_write_b128 v145, v[56:59] offset:3072
v_mfma_f32_16x16x32_bf16 v[72:75], v[188:191], a[72:75], v[72:75]
v_mfma_f32_16x16x32_bf16 v[76:79], v[192:195], a[72:75], v[76:79]
ds_write_b128 v145, v[60:63] offset:4096
v_mfma_f32_16x16x32_bf16 v[80:83], v[196:199], a[72:75], v[80:83]
buffer_load_dwordx4 v[240:243], v1, s[4:7], s38 offen offset:2048
s_waitcnt vmcnt(14)
v_mfma_f32_16x16x32_bf16 v[84:87], a[252:255], a[60:63], v[84:87]
ds_write_b128 v146, v[64:67] offset:5120
v_mfma_f32_16x16x32_bf16 v[88:91], v[164:167], a[60:63], v[88:91]
v_mfma_f32_16x16x32_bf16 v[92:95], v[168:171], a[60:63], v[92:95]
ds_write_b128 v146, v[68:71] offset:6144
buffer_load_dwordx4 v[244:247], v1, s[4:7], s38 offen offset:3072
v_mfma_f32_16x16x32_bf16 v[96:99], v[172:175], a[60:63], v[96:99]
v_mfma_f32_16x16x32_bf16 v[100:103], v[176:179], a[60:63], v[100:103]
ds_write_b128 v146, v[72:75] offset:7168
s_waitcnt vmcnt(14)
v_mfma_f32_16x16x32_bf16 v[84:87], v[180:183], a[76:79], v[84:87]
v_mfma_f32_16x16x32_bf16 v[88:91], v[184:187], a[76:79], v[88:91]
ds_write_b128 v146, v[76:79] offset:8192
s_add_u32 s38, s14, 8426496
buffer_load_dwordx4 v[248:251], v1, s[4:7], s38 offen offset:0
v_mfma_f32_16x16x32_bf16 v[92:95], v[188:191], a[76:79], v[92:95]
v_mfma_f32_16x16x32_bf16 v[96:99], v[192:195], a[76:79], v[96:99]
ds_write_b128 v146, v[80:83] offset:9216
v_mfma_f32_16x16x32_bf16 v[100:103], v[196:199], a[76:79], v[100:103]
buffer_load_dwordx4 v[252:255], v1, s[4:7], s38 offen offset:1024
s_waitcnt vmcnt(15)
v_mfma_f32_16x16x32_bf16 v[24:27], a[252:255], a[48:51], v[24:27]
ds_write_b128 v147, v[84:87] offset:10240
v_mfma_f32_16x16x32_bf16 v[28:31], v[164:167], a[48:51], v[28:31]
v_mfma_f32_16x16x32_bf16 v[32:35], v[168:171], a[48:51], v[32:35]
ds_write_b128 v147, v[88:91] offset:11264
v_mfma_f32_16x16x32_bf16 v[36:39], v[172:175], a[48:51], v[36:39]
buffer_load_dwordx4 a[188:191], v1, s[4:7], s38 offen offset:2048
v_mfma_f32_16x16x32_bf16 v[40:43], v[176:179], a[48:51], v[40:43]
ds_write_b128 v147, v[92:95] offset:12288
s_waitcnt vmcnt(14)
v_mfma_f32_16x16x32_bf16 v[24:27], v[180:183], a[64:67], v[24:27]
v_mfma_f32_16x16x32_bf16 v[28:31], v[184:187], a[64:67], v[28:31]
ds_write_b128 v147, v[96:99] offset:13312
v_mfma_f32_16x16x32_bf16 v[32:35], v[188:191], a[64:67], v[32:35]
v_mfma_f32_16x16x32_bf16 v[36:39], v[192:195], a[64:67], v[36:39]
ds_write_b128 v147, v[100:103] offset:14336
v_mfma_f32_16x16x32_bf16 v[40:43], v[196:199], a[64:67], v[40:43]
s_waitcnt lgkmcnt(0)
s_barrier
ds_read_b128 v[44:47], v144 offset:0
ds_read_b128 v[48:51], v144 offset:5120
ds_read_b128 v[52:55], v144 offset:10240
ds_read_b128 v[56:59], v144 offset:1024
ds_read_b128 v[60:63], v144 offset:6144
ds_read_b128 v[64:67], v144 offset:11264
ds_read_b128 v[68:71], v144 offset:2048
ds_read_b128 v[72:75], v144 offset:7168
ds_read_b128 v[76:79], v144 offset:12288
ds_read_b128 v[80:83], v144 offset:3072
ds_read_b128 v[84:87], v144 offset:8192
ds_read_b128 v[88:91], v144 offset:13312
ds_read_b128 v[92:95], v144 offset:4096
ds_read_b128 v[96:99], v144 offset:9216
ds_read_b128 v[100:103], v144 offset:14336
s_mul_i32 s99, s32, 20480
s_mul_i32 s22, s21, 2560
s_add_u32 s99, s99, s22
s_add_u32 s99, s99, s28
s_add_u32 s99, s99, 13238272
s_lshl_b32 s100, s32, 10
s_lshl_b32 s22, s21, 7
s_add_u32 s100, s100, s22
v_lshrrev_b32 v114, 1, v19
s_add_u32 s100, s100, s29
s_add_u32 s100, s100, 21233664
s_add_u32 s38, s14, 8429568
buffer_load_dwordx4 a[192:195], v1, s[4:7], s38 offen offset:0
buffer_load_dwordx4 a[196:199], v1, s[4:7], s38 offen offset:1024
s_waitcnt lgkmcnt(14)
v_pk_add_f32 v[24:25], v[24:25], v[44:45]
v_pk_add_f32 v[26:27], v[26:27], v[46:47]
s_waitcnt lgkmcnt(12)
v_pk_add_f32 v[48:49], v[48:49], v[52:53]
v_pk_add_f32 v[50:51], v[50:51], v[54:55]
v_pk_add_f32 v[24:25], v[24:25], v[48:49]
v_pk_add_f32 v[26:27], v[26:27], v[50:51]
v_cvt_pk_bf16_f32 v4, v24, v25
buffer_load_dwordx4 a[200:203], v1, s[4:7], s38 offen offset:2048
v_cvt_pk_bf16_f32 v5, v26, v27
s_waitcnt lgkmcnt(11)
v_pk_add_f32 v[28:29], v[28:29], v[56:57]
v_pk_add_f32 v[30:31], v[30:31], v[58:59]
s_waitcnt lgkmcnt(9)
v_pk_add_f32 v[60:61], v[60:61], v[64:65]
v_pk_add_f32 v[62:63], v[62:63], v[66:67]
v_pk_add_f32 v[28:29], v[28:29], v[60:61]
v_pk_add_f32 v[30:31], v[30:31], v[62:63]
buffer_load_dwordx4 a[204:207], v1, s[4:7], s38 offen offset:3072
v_cvt_pk_bf16_f32 v6, v28, v29
v_cvt_pk_bf16_f32 v7, v30, v31
s_waitcnt lgkmcnt(8)
v_pk_add_f32 v[32:33], v[32:33], v[68:69]
v_pk_add_f32 v[34:35], v[34:35], v[70:71]
s_waitcnt lgkmcnt(6)
v_pk_add_f32 v[72:73], v[72:73], v[76:77]
v_pk_add_f32 v[74:75], v[74:75], v[78:79]
s_add_u32 s38, s14, 8433664
buffer_load_dwordx4 a[208:211], v1, s[4:7], s38 offen offset:0
v_pk_add_f32 v[32:33], v[32:33], v[72:73]
v_pk_add_f32 v[34:35], v[34:35], v[74:75]
v_cvt_pk_bf16_f32 v8, v32, v33
v_cvt_pk_bf16_f32 v9, v34, v35
s_waitcnt lgkmcnt(5)
v_pk_add_f32 v[36:37], v[36:37], v[80:81]
v_pk_add_f32 v[38:39], v[38:39], v[82:83]
s_waitcnt lgkmcnt(3)
v_pk_add_f32 v[84:85], v[84:85], v[88:89]
buffer_load_dwordx4 a[212:215], v1, s[4:7], s38 offen offset:1024
v_pk_add_f32 v[86:87], v[86:87], v[90:91]
v_pk_add_f32 v[36:37], v[36:37], v[84:85]
v_pk_add_f32 v[38:39], v[38:39], v[86:87]
v_cvt_pk_bf16_f32 v10, v36, v37
v_cvt_pk_bf16_f32 v11, v38, v39
s_waitcnt lgkmcnt(2)
v_pk_add_f32 v[40:41], v[40:41], v[92:93]
v_pk_add_f32 v[42:43], v[42:43], v[94:95]
s_waitcnt lgkmcnt(0)
v_pk_add_f32 v[96:97], v[96:97], v[100:101]
v_pk_add_f32 v[98:99], v[98:99], v[102:103]
v_pk_add_f32 v[40:41], v[40:41], v[96:97]
v_pk_add_f32 v[42:43], v[42:43], v[98:99]
v_cvt_pk_bf16_f32 v12, v40, v41
v_cvt_pk_bf16_f32 v13, v42, v43
buffer_store_dwordx4 v[4:7], v1, s[4:7], s99 offen sc1
buffer_store_dwordx4 v[8:11], v1, s[4:7], s99 offen offset:1024 sc1
buffer_store_dwordx2 v[12:13], v17, s[4:7], s99 offen offset:2048 sc1
v_pk_add_f32 v[108:109], v[24:25], v[26:27]
v_pk_mul_f32 v[110:111], v[24:25], v[24:25]
v_pk_fma_f32 v[110:111], v[26:27], v[26:27], v[110:111]
v_pk_add_f32 v[108:109], v[108:109], v[28:29]
v_pk_fma_f32 v[110:111], v[28:29], v[28:29], v[110:111]
v_pk_add_f32 v[108:109], v[108:109], v[30:31]
v_pk_fma_f32 v[110:111], v[30:31], v[30:31], v[110:111]
v_pk_add_f32 v[108:109], v[108:109], v[32:33]
v_pk_fma_f32 v[110:111], v[32:33], v[32:33], v[110:111]
v_pk_add_f32 v[108:109], v[108:109], v[34:35]
v_pk_fma_f32 v[110:111], v[34:35], v[34:35], v[110:111]
v_pk_add_f32 v[108:109], v[108:109], v[36:37]
v_pk_fma_f32 v[110:111], v[36:37], v[36:37], v[110:111]
v_pk_add_f32 v[108:109], v[108:109], v[38:39]
v_pk_fma_f32 v[110:111], v[38:39], v[38:39], v[110:111]
v_pk_add_f32 v[108:109], v[108:109], v[40:41]
v_pk_fma_f32 v[110:111], v[40:41], v[40:41], v[110:111]
v_pk_add_f32 v[108:109], v[108:109], v[42:43]
v_pk_fma_f32 v[110:111], v[42:43], v[42:43], v[110:111]
v_add_f32 v112, v108, v109
v_add_f32 v113, v110, v111
v_mov_b32 v104, v112
v_mov_b32 v105, v113
s_nop 0
v_permlane32_swap_b32 v112, v104
v_permlane32_swap_b32 v113, v105
v_add_f32 v112, v112, v104
v_add_f32 v113, v113, v105
v_mov_b32 v104, v112
v_mov_b32 v105, v113
s_nop 0
v_permlane16_swap_b32 v112, v104
v_permlane16_swap_b32 v113, v105
v_add_f32 v112, v112, v104
v_add_f32 v113, v113, v105
buffer_store_dwordx2 v[112:113], v114, s[4:7], s100 offen sc1
v_lshlrev_b32 v23, 8, v0
s_lshl_b32 s22, s17, 12
s_add_u32 s22, s22, s30
v_cndmask_b32 v23, v22, v23, s[40:41]
s_waitcnt vmcnt(0)
s_barrier
s_cmp_eq_u32 s16, 0
s_cbranch_scc0 L_if31
buffer_atomic_add v21, v23, s[4:7], s22 offen offset:8 sc1
L_if31:
s_cmp_eq_u32 s16, 0
s_cbranch_scc1 L_if32
s_mul_i32 s24, s16, 20480
s_add_u32 s25, s98, s24
s_add_u32 s26, s25, 3784704
s_add_u32 m0, s24, 81920
s_nop 0
buffer_load_dwordx4 v1, s[4:7], s26 offen offset:0 lds
buffer_load_dwordx4 v1, s[4:7], s26 offen offset:1024 lds
buffer_load_dwordx4 v1, s[4:7], s26 offen offset:2048 lds
buffer_load_dwordx4 v1, s[4:7], s26 offen offset:3072 lds
s_add_u32 s26, s25, 3788800
s_add_u32 m0, s24, 86016
s_nop 0
buffer_load_dwordx4 v1, s[4:7], s26 offen offset:0 lds
buffer_load_dwordx4 v1, s[4:7], s26 offen offset:1024 lds
buffer_load_dwordx4 v1, s[4:7], s26 offen offset:2048 lds
buffer_load_dwordx4 v1, s[4:7], s26 offen offset:3072 lds
s_add_u32 s26, s25, 3792896
s_add_u32 m0, s24, 90112
s_nop 0
buffer_load_dwordx4 v1, s[4:7], s26 offen offset:0 lds
buffer_load_dwordx4 v1, s[4:7], s26 offen offset:1024 lds
buffer_load_dwordx4 v1, s[4:7], s26 offen offset:2048 lds
buffer_load_dwordx4 v1, s[4:7], s26 offen offset:3072 lds
s_add_u32 s26, s25, 3796992
s_add_u32 m0, s24, 94208
s_nop 0
buffer_load_dwordx4 v1, s[4:7], s26 offen offset:0 lds
buffer_load_dwordx4 v1, s[4:7], s26 offen offset:1024 lds
buffer_load_dwordx4 v1, s[4:7], s26 offen offset:2048 lds
buffer_load_dwordx4 v1, s[4:7], s26 offen offset:3072 lds
s_add_u32 s26, s25, 3801088
s_add_u32 m0, s24, 98304
s_nop 0
buffer_load_dwordx4 v1, s[4:7], s26 offen offset:0 lds
buffer_load_dwordx4 v1, s[4:7], s26 offen offset:1024 lds
buffer_load_dwordx4 v1, s[4:7], s26 offen offset:2048 lds
buffer_load_dwordx4 v1, s[4:7], s26 offen offset:3072 lds
L_if32:
s_lshl_b32 s25, s31, 10
s_add_u32 s27, s25, s29
s_add_u32 s27, s27, 21233664
s_mul_i32 s100, s31, 20480
s_add_u32 s100, s100, s28
s_mul_i32 s23, s31, 57344
s_mul_i32 s22, s19, 7340032
s_add_u32 s23, s23, s22
s_add_u32 s23, s23, 26869760
s_lshl_b32 s22, s18, 11
s_add_u32 s12, s23, s22
s_mul_i32 s22, s18, 1536
s_add_u32 s15, s23, s22
s_add_u32 s15, s15, 32256
s_cmp_eq_u32 s18, 15
s_mov_b32 s22, 1536
s_cmov_b32 s22, 26112
s_add_u32 s96, s12, s22
s_mul_i32 s14, s16, 10240
s_min_u32 s22, s18, 14
s_mul_i32 s22, s22, 286720
s_add_u32 s13, s22, s14
s_mul_i32 s98, s21, 276480
s_mul_i32 s22, s16, 40960
s_add_u32 s99, s98, s22
s_cmp_eq_u32 s16, 0
s_cbranch_scc0 L_if33
s_lshl_b32 s101, s17, 4
s_add_u32 s101, s101, s18
s_lshl_b32 s101, s101, 8
s_add_u32 s101, s101, s30
v_mov_b32 v23, 0
buffer_atomic_add v23, v22, s[4:7], s101 offen offset:8 sc0 sc1
L_if33:
s_cmp_eq_u32 s16, 0
s_cbranch_scc0 L_if34
s_waitcnt vmcnt(0)
v_readfirstlane_b32 s23, v23
s_mov_b32 s33, 0
s_cmp_ge_u32 s23, 16
s_cbranch_scc1 L_polld4
L_poll4:
v_mov_b32 v23, 0
buffer_atomic_add v23, v22, s[4:7], s101 offen offset:8 sc0 sc1
s_waitcnt vmcnt(0)
v_readfirstlane_b32 s23, v23
s_add_u32 s33, s33, 1
s_cmp_ge_u32 s23, 16
s_cbranch_scc1 L_polld4
s_cmp_lt_u32 s33, 400000
s_cbranch_scc1 L_poll4
L_polld4:
L_if34:
s_barrier
s_add_u32 s38, s100, 13238272
buffer_load_dwordx4 a[0:3], v14, s[4:7], s38 offen offset:0 sc1
buffer_load_dwordx4 a[4:7], v14, s[4:7], s38 offen offset:512 sc1
buffer_load_dwordx4 a[8:11], v14, s[4:7], s38 offen offset:1024 sc1
buffer_load_dwordx4 a[12:15], v14, s[4:7], s38 offen offset:1536 sc1
buffer_load_dwordx4 a[16:19], v14, s[4:7], s38 offen offset:2048 sc1
buffer_load_dwordx4 a[20:23], v14, s[4:7], s38 offen offset:2560 sc1
buffer_load_dwordx4 a[24:27], v14, s[4:7], s38 offen offset:3072 sc1
buffer_load_dwordx4 a[28:31], v14, s[4:7], s38 offen offset:3584 sc1
s_waitcnt vmcnt(8)
s_barrier
buffer_load_dwordx2 v[136:137], v16, s[4:7], s27 offen offset:0 sc1
buffer_load_dwordx2 v[138:139], v16, s[4:7], s27 offen offset:128 sc1
buffer_load_dwordx2 v[140:141], v16, s[4:7], s27 offen offset:256 sc1
buffer_load_dwordx2 v[142:143], v16, s[4:7], s27 offen offset:384 sc1
ds_read_b128 v[104:107], v1 offset:0
ds_read_b128 v[108:111], v1 offset:1024
ds_read_b128 v[112:115], v1 offset:2048
ds_read_b128 v[116:119], v1 offset:3072
ds_read_b128 v[120:123], v1 offset:4096
ds_read_b128 v[124:127], v1 offset:5120
s_waitcnt vmcnt(10) lgkmcnt(4)
v_mfma_f32_32x32x16_bf16 v[24:39], v[104:107], a[0:3], 0
ds_read_b128 v[128:131], v1 offset:6144
v_mfma_f32_32x32x16_bf16 v[40:55], v[108:111], a[0:3], 0
ds_read_b128 v[132:135], v1 offset:7168
s_waitcnt lgkmcnt(4)
v_mfma_f32_32x32x16_bf16 v[56:71], v[112:115], a[0:3], 0
ds_read_b128 v[104:107], v1 offset:8192
s_add_u32 s38, s100, 13242368
buffer_load_dwordx4 a[32:35], v14, s[4:7], s38 offen offset:0 sc1
v_mfma_f32_32x32x16_bf16 v[72:87], v[116:119], a[0:3], 0
ds_read_b128 v[108:111], v1 offset:9216
s_waitcnt lgkmcnt(4)
v_mfma_f32_32x32x16_bf16 v[24:39], v[120:123], a[4:7], v[24:39]
ds_read_b128 v[112:115], v1 offset:10240
buffer_load_dwordx4 a[36:39], v14, s[4:7], s38 offen offset:512 sc1
v_mfma_f32_32x32x16_bf16 v[40:55], v[124:127], a[4:7], v[40:55]
ds_read_b128 v[116:119], v1 offset:11264
s_waitcnt lgkmcnt(4)
v_mfma_f32_32x32x16_bf16 v[56:71], v[128:131], a[4:7], v[56:71]
ds_read_b128 v[120:123], v1 offset:12288
buffer_load_dwordx4 a[40:43], v14, s[4:7], s38 offen offset:1024 sc1
v_mfma_f32_32x32x16_bf16 v[72:87], v[132:135], a[4:7], v[72:87]
ds_read_b128 v[124:127], v1 offset:13312
s_waitcnt vmcnt(11) lgkmcnt(4)
v_mfma_f32_32x32x16_bf16 v[24:39], v[104:107], a[8:11], v[24:39]
ds_read_b128 v[128:131], v1 offset:14336
buffer_load_dwordx4 a[44:47], v14, s[4:7], s38 offen offset:1536 sc1
v_mfma_f32_32x32x16_bf16 v[40:55], v[108:111], a[8:11], v[40:55]
ds_read_b128 v[132:135], v1 offset:15360
s_waitcnt lgkmcnt(4)
v_mfma_f32_32x32x16_bf16 v[56:71], v[112:115], a[8:11], v[56:71]
ds_read_b128 v[104:107], v1 offset:16384
v_mfma_f32_32x32x16_bf16 v[72:87], v[116:119], a[8:11], v[72:87]
ds_read_b128 v[108:111], v1 offset:17408
buffer_load_dwordx4 a[48:51], v14, s[4:7], s38 offen offset:2048 sc1
s_waitcnt lgkmcnt(4)
v_mfma_f32_32x32x16_bf16 v[24:39], v[120:123], a[12:15], v[24:39]
ds_read_b128 v[112:115], v1 offset:18432
v_mfma_f32_32x32x16_bf16 v[40:55], v[124:127], a[12:15], v[40:55]
ds_read_b128 v[116:119], v1 offset:19456
buffer_load_dwordx4 a[52:55], v14, s[4:7], s38 offen offset:2560 sc1
s_waitcnt lgkmcnt(4)
v_mfma_f32_32x32x16_bf16 v[56:71], v[128:131], a[12:15], v[56:71]
ds_read_b128 v[120:123], v1 offset:20480
v_mfma_f32_32x32x16_bf16 v[72:87], v[132:135], a[12:15], v[72:87]
ds_read_b128 v[124:127], v1 offset:21504
buffer_load_dwordx4 a[56:59], v14, s[4:7], s38 offen offset:3072 sc1
s_waitcnt vmcnt(13) lgkmcnt(4)
v_mfma_f32_32x32x16_bf16 v[24:39], v[104:107], a[16:19], v[24:39]
ds_read_b128 v[128:131], v1 offset:22528
v_mfma_f32_32x32x16_bf16 v[40:55], v[108:111], a[16:19], v[40:55]
ds_read_b128 v[132:135], v1 offset:23552
buffer_load_dwordx4 a[60:63], v14, s[4:7], s38 offen offset:3584 sc1
s_waitcnt lgkmcnt(4)
v_mfma_f32_32x32x16_bf16 v[56:71], v[112:115], a[16:19], v[56:71]
ds_read_b128 v[104:107], v1 offset:24576
v_mfma_f32_32x32x16_bf16 v[72:87], v[116:119], a[16:19], v[72:87]
ds_read_b128 v[108:111], v1 offset:25600
s_add_u32 s38, s100, 13246464
buffer_load_dwordx4 a[64:67], v14, s[4:7], s38 offen offset:0 sc1
s_waitcnt lgkmcnt(4)
v_mfma_f32_32x32x16_bf16 v[24:39], v[120:123], a[20:23], v[24:39]
ds_read_b128 v[112:115], v1 offset:26624
v_mfma_f32_32x32x16_bf16 v[40:55], v[124:127], a[20:23], v[40:55]
ds_read_b128 v[116:119], v1 offset:27648
s_waitcnt lgkmcnt(4)
v_mfma_f32_32x32x16_bf16 v[56:71], v[128:131], a[20:23], v[56:71]
ds_read_b128 v[120:123], v1 offset:28672
buffer_load_dwordx4 a[68:71], v14, s[4:7], s38 offen offset:512 sc1
v_mfma_f32_32x32x16_bf16 v[72:87], v[132:135], a[20:23], v[72:87]
ds_read_b128 v[124:127], v1 offset:29696
s_waitcnt vmcnt(14) lgkmcnt(4)
v_mfma_f32_32x32x16_bf16 v[24:39], v[104:107], a[24:27], v[24:39]
ds_read_b128 v[128:131], v1 offset:30720
buffer_load_dwordx4 a[72:75], v14, s[4:7], s38 offen offset:1024 sc1
v_mfma_f32_32x32x16_bf16 v[40:55], v[108:111], a[24:27], v[40:55]
ds_read_b128 v[132:135], v1 offset:31744
s_waitcnt lgkmcnt(4)
v_mfma_f32_32x32x16_bf16 v[56:71], v[112:115], a[24:27], v[56:71]
ds_read_b128 v[104:107], v1 offset:32768
buffer_load_dwordx4 a[76:79], v14, s[4:7], s38 offen offset:1536 sc1
v_mfma_f32_32x32x16_bf16 v[72:87], v[116:119], a[24:27], v[72:87]
ds_read_b128 v[108:111], v1 offset:33792
s_waitcnt lgkmcnt(4)
v_mfma_f32_32x32x16_bf16 v[24:39], v[120:123], a[28:31], v[24:39]
ds_read_b128 v[112:115], v1 offset:34816
buffer_load_dwordx4 a[80:83], v14, s[4:7], s38 offen offset:2048 sc1
v_mfma_f32_32x32x16_bf16 v[40:55], v[124:127], a[28:31], v[40:55]
ds_read_b128 v[116:119], v1 offset:35840
s_waitcnt lgkmcnt(4)
v_mfma_f32_32x32x16_bf16 v[56:71], v[128:131], a[28:31], v[56:71]
ds_read_b128 v[120:123], v1 offset:36864
s_waitcnt vmcnt(15)
v_add_f32 v136, v136, v138
v_add_f32 v137, v137, v139
s_waitcnt vmcnt(13)
v_add_f32 v140, v140, v142
v_add_f32 v141, v141, v143
v_add_f32 v136, v136, v140
v_mfma_f32_32x32x16_bf16 v[72:87], v[132:135], a[28:31], v[72:87]
ds_read_b128 v[124:127], v1 offset:37888
buffer_load_dwordx4 a[84:87], v14, s[4:7], s38 offen offset:2560 sc1
v_add_f32 v137, v137, v141
v_mov_b32 v152, v136
v_mov_b32 v153, v137
s_nop 0
v_permlane32_swap_b32 v136, v152
s_waitcnt vmcnt(12) lgkmcnt(4)
v_mfma_f32_32x32x16_bf16 v[24:39], v[104:107], a[32:35], v[24:39]
ds_read_b128 v[128:131], v1 offset:38912
v_permlane32_swap_b32 v137, v153
v_add_f32 v136, v136, v152
v_add_f32 v137, v137, v153
v_mul_f32 v136, 0xbacccccd, v136
v_mfma_f32_32x32x16_bf16 v[40:55], v[108:111], a[32:35], v[40:55]
ds_read_b128 v[132:135], v1 offset:39936
buffer_load_dwordx4 a[88:91], v14, s[4:7], s38 offen offset:3072 sc1
v_mul_f32 v152, v136, v136
v_mul_f32 v137, 0x3acccccd, v137
v_sub_f32 v137, v137, v152
v_max_f32 v137, 0, v137
s_waitcnt lgkmcnt(4)
v_mfma_f32_32x32x16_bf16 v[56:71], v[112:115], a[32:35], v[56:71]
ds_read_b128 v[104:107], v1 offset:40960
v_add_f32 v137, 0x3727c5ac, v137
v_rsq_f32 v148, v137
v_mfma_f32_32x32x16_bf16 v[72:87], v[116:119], a[32:35], v[72:87]
ds_read_b128 v[108:111], v1 offset:41984
buffer_load_dwordx4 a[92:95], v14, s[4:7], s38 offen offset:3584 sc1
v_sqrt_f32 v150, v137
v_cvt_pk_bf16_f32 v144, v136, v136
v_lshlrev_b32 v152, 16, v144
s_waitcnt lgkmcnt(4)
v_mfma_f32_32x32x16_bf16 v[24:39], v[120:123], a[36:39], v[24:39]
ds_read_b128 v[112:115], v1 offset:43008
v_sub_f32 v152, v136, v152
v_cvt_pk_bf16_f32 v145, v152, 0
v_mov_b32 v146, v144
v_mov_b32 v147, v145
v_mfma_f32_32x32x16_bf16 v[40:55], v[124:127], a[36:39], v[40:55]
ds_read_b128 v[116:119], v1 offset:44032
s_add_u32 s38, s100, 13250560
buffer_load_dwordx4 a[96:99], v14, s[4:7], s38 offen offset:0 sc1
v_mul_f32 v148, 0xbfb8aa3b, v148
s_mul_i32 s22, s16, 6
s_add_u32 s22, s22, 31
s_waitcnt lgkmcnt(4)
v_mfma_f32_32x32x16_bf16 v[56:71], v[128:131], a[36:39], v[56:71]
ds_read_b128 v[120:123], v1 offset:45056
s_min_u32 s22, s22, 48
s_mul_i32 s22, s22, 5120
s_add_u32 s3, s98, s22
s_mul_i32 s59, s16, 5120
v_mfma_f32_32x32x16_bf16 v[72:87], v[132:135], a[36:39], v[72:87]
ds_read_b128 v[124:127], v1 offset:46080
buffer_load_dwordx4 a[100:103], v14, s[4:7], s38 offen offset:512 sc1
s_waitcnt vmcnt(14) lgkmcnt(4)
v_mfma_f32_32x32x16_bf16 v[24:39], v[104:107], a[40:43], v[24:39]
ds_read_b128 v[128:131], v1 offset:47104
v_mfma_f32_32x32x16_bf16 v[40:55], v[108:111], a[40:43], v[40:55]
ds_read_b128 v[132:135], v1 offset:48128
s_waitcnt lgkmcnt(4)
v_mfma_f32_32x32x16_bf16 v[56:71], v[112:115], a[40:43], v[56:71]
ds_read_b128 v[104:107], v1 offset:49152
buffer_load_dwordx4 a[104:107], v14, s[4:7], s38 offen offset:1024 sc1
v_mfma_f32_32x32x16_bf16 v[72:87], v[116:119], a[40:43], v[72:87]
ds_read_b128 v[108:111], v1 offset:50176
s_waitcnt lgkmcnt(4)
v_mfma_f32_32x32x16_bf16 v[24:39], v[120:123], a[44:47], v[24:39]
ds_read_b128 v[112:115], v1 offset:51200
buffer_load_dwordx4 a[108:111], v14, s[4:7], s38 offen offset:1536 sc1
v_mfma_f32_32x32x16_bf16 v[40:55], v[124:127], a[44:47], v[40:55]
ds_read_b128 v[116:119], v1 offset:52224
s_waitcnt lgkmcnt(4)
v_mfma_f32_32x32x16_bf16 v[56:71], v[128:131], a[44:47], v[56:71]
ds_read_b128 v[120:123], v1 offset:53248
buffer_load_dwordx4 a[112:115], v14, s[4:7], s38 offen offset:2048 sc1
v_mfma_f32_32x32x16_bf16 v[72:87], v[132:135], a[44:47], v[72:87]
ds_read_b128 v[124:127], v1 offset:54272
s_waitcnt vmcnt(15) lgkmcnt(4)
v_mfma_f32_32x32x16_bf16 v[24:39], v[104:107], a[48:51], v[24:39]
ds_read_b128 v[128:131], v1 offset:55296
buffer_load_dwordx4 a[116:119], v14, s[4:7], s38 offen offset:2560 sc1
v_mfma_f32_32x32x16_bf16 v[40:55], v[108:111], a[48:51], v[40:55]
ds_read_b128 v[132:135], v1 offset:56320
s_waitcnt lgkmcnt(4)
v_mfma_f32_32x32x16_bf16 v[56:71], v[112:115], a[48:51], v[56:71]
ds_read_b128 v[104:107], v1 offset:57344
v_mfma_f32_32x32x16_bf16 v[72:87], v[116:119], a[48:51], v[72:87]
ds_read_b128 v[108:111], v1 offset:58368
buffer_load_dwordx4 a[120:123], v14, s[4:7], s38 offen offset:3072 sc1
s_waitcnt lgkmcnt(4)
v_mfma_f32_32x32x16_bf16 v[24:39], v[120:123], a[52:55], v[24:39]
ds_read_b128 v[112:115], v1 offset:59392
v_mfma_f32_32x32x16_bf16 v[40:55], v[124:127], a[52:55], v[40:55]
ds_read_b128 v[116:119], v1 offset:60416
buffer_load_dwordx4 a[124:127], v14, s[4:7], s38 offen offset:3584 sc1
s_waitcnt lgkmcnt(4)
v_mfma_f32_32x32x16_bf16 v[56:71], v[128:131], a[52:55], v[56:71]
ds_read_b128 v[120:123], v1 offset:61440
v_mfma_f32_32x32x16_bf16 v[72:87], v[132:135], a[52:55], v[72:87]
ds_read_b128 v[124:127], v1 offset:62464
s_add_u32 s38, s100, 13254656
buffer_load_dwordx4 a[128:131], v14, s[4:7], s38 offen offset:0 sc1
s_waitcnt vmcnt(17) lgkmcnt(4)
v_mfma_f32_32x32x16_bf16 v[24:39], v[104:107], a[56:59], v[24:39]
ds_read_b128 v[128:131], v1 offset:63488
v_mfma_f32_32x32x16_bf16 v[40:55], v[108:111], a[56:59], v[40:55]
ds_read_b128 v[132:135], v1 offset:64512
buffer_load_dwordx4 a[132:135], v14, s[4:7], s38 offen offset:512 sc1
s_waitcnt lgkmcnt(4)
v_mfma_f32_32x32x16_bf16 v[56:71], v[112:115], a[56:59], v[56:71]
ds_read_b128 v[104:107], v2 offset:0
v_mfma_f32_32x32x16_bf16 v[72:87], v[116:119], a[56:59], v[72:87]
ds_read_b128 v[108:111], v2 offset:1024
buffer_load_dwordx4 a[136:139], v14, s[4:7], s38 offen offset:1024 sc1
s_waitcnt lgkmcnt(4)
v_mfma_f32_32x32x16_bf16 v[24:39], v[120:123], a[60:63], v[24:39]
ds_read_b128 v[112:115], v2 offset:2048
v_mfma_f32_32x32x16_bf16 v[40:55], v[124:127], a[60:63], v[40:55]
ds_read_b128 v[116:119], v2 offset:3072
s_waitcnt lgkmcnt(4)
v_mfma_f32_32x32x16_bf16 v[56:71], v[128:131], a[60:63], v[56:71]
ds_read_b128 v[120:123], v2 offset:4096
buffer_load_dwordx4 a[140:143], v14, s[4:7], s38 offen offset:1536 sc1
v_mfma_f32_32x32x16_bf16 v[72:87], v[132:135], a[60:63], v[72:87]
ds_read_b128 v[124:127], v2 offset:5120
s_waitcnt vmcnt(18) lgkmcnt(4)
v_mfma_f32_32x32x16_bf16 v[24:39], v[104:107], a[64:67], v[24:39]
ds_read_b128 v[128:131], v2 offset:6144
buffer_load_dwordx4 a[144:147], v14, s[4:7], s38 offen offset:2048 sc1
v_mfma_f32_32x32x16_bf16 v[40:55], v[108:111], a[64:67], v[40:55]
ds_read_b128 v[132:135], v2 offset:7168
s_waitcnt lgkmcnt(4)
v_mfma_f32_32x32x16_bf16 v[56:71], v[112:115], a[64:67], v[56:71]
ds_read_b128 v[104:107], v2 offset:8192
buffer_load_dwordx4 a[148:151], v14, s[4:7], s38 offen offset:2560 sc1
v_mfma_f32_32x32x16_bf16 v[72:87], v[116:119], a[64:67], v[72:87]
ds_read_b128 v[108:111], v2 offset:9216
s_waitcnt lgkmcnt(4)
v_mfma_f32_32x32x16_bf16 v[24:39], v[120:123], a[68:71], v[24:39]
ds_read_b128 v[112:115], v2 offset:10240
buffer_load_dwordx4 a[152:155], v14, s[4:7], s38 offen offset:3072 sc1
v_mfma_f32_32x32x16_bf16 v[40:55], v[124:127], a[68:71], v[40:55]
ds_read_b128 v[116:119], v2 offset:11264
s_waitcnt lgkmcnt(4)
v_mfma_f32_32x32x16_bf16 v[56:71], v[128:131], a[68:71], v[56:71]
ds_read_b128 v[120:123], v2 offset:12288
v_mfma_f32_32x32x16_bf16 v[72:87], v[132:135], a[68:71], v[72:87]
ds_read_b128 v[124:127], v2 offset:13312
buffer_load_dwordx4 a[156:159], v14, s[4:7], s38 offen offset:3584 sc1
s_waitcnt vmcnt(20) lgkmcnt(4)
v_mfma_f32_32x32x16_bf16 v[24:39], v[104:107], a[72:75], v[24:39]
ds_read_b128 v[128:131], v2 offset:14336
v_mfma_f32_32x32x16_bf16 v[40:55], v[108:111], a[72:75], v[40:55]
ds_read_b128 v[132:135], v2 offset:15360
s_add_u32 s97, s99, 8404992
buffer_load_dwordx4 v[164:167], v1, s[4:7], s97 offen offset:0
s_waitcnt lgkmcnt(4)
v_mfma_f32_32x32x16_bf16 v[56:71], v[112:115], a[72:75], v[56:71]
ds_read_b128 v[104:107], v2 offset:16384
v_mfma_f32_32x32x16_bf16 v[72:87], v[116:119], a[72:75], v[72:87]
ds_read_b128 v[108:111], v2 offset:17408
buffer_load_dwordx4 v[168:171], v1, s[4:7], s97 offen offset:1024
s_waitcnt lgkmcnt(4)
v_mfma_f32_32x32x16_bf16 v[24:39], v[120:123], a[76:79], v[24:39]
ds_read_b128 v[112:115], v2 offset:18432
v_mfma_f32_32x32x16_bf16 v[40:55], v[124:127], a[76:79], v[40:55]
ds_read_b128 v[116:119], v2 offset:19456
buffer_load_dwordx4 v[172:175], v1, s[4:7], s97 offen offset:2048
s_waitcnt lgkmcnt(4)
v_mfma_f32_32x32x16_bf16 v[56:71], v[128:131], a[76:79], v[56:71]
ds_read_b128 v[120:123], v2 offset:20480
v_mfma_f32_32x32x16_bf16 v[72:87], v[132:135], a[76:79], v[72:87]
ds_read_b128 v[124:127], v2 offset:21504
buffer_load_dwordx4 v[176:179], v1, s[4:7], s97 offen offset:3072
s_barrier
s_waitcnt vmcnt(22) lgkmcnt(4)
v_mfma_f32_32x32x16_bf16 v[24:39], v[104:107], a[80:83], v[24:39]
ds_read_b128 v[128:131], v2 offset:22528
v_mfma_f32_32x32x16_bf16 v[40:55], v[108:111], a[80:83], v[40:55]
ds_read_b128 v[132:135], v2 offset:23552
s_waitcnt lgkmcnt(4)
v_mfma_f32_32x32x16_bf16 v[56:71], v[112:115], a[80:83], v[56:71]
ds_read_b128 v[104:107], v2 offset:24576
s_add_u32 s39, s13, 3866624
s_add_u32 m0, s14, 0
s_nop 0
buffer_load_dwordx4 v1, s[4:7], s39 offen offset:0 lds
v_mfma_f32_32x32x16_bf16 v[72:87], v[116:119], a[80:83], v[72:87]
ds_read_b128 v[108:111], v2 offset:25600
s_waitcnt lgkmcnt(4)
v_mfma_f32_32x32x16_bf16 v[24:39], v[120:123], a[84:87], v[24:39]
ds_read_b128 v[112:115], v2 offset:26624
buffer_load_dwordx4 v1, s[4:7], s39 offen offset:1024 lds
v_mfma_f32_32x32x16_bf16 v[40:55], v[124:127], a[84:87], v[40:55]
ds_read_b128 v[116:119], v2 offset:27648
s_waitcnt lgkmcnt(4)
v_mfma_f32_32x32x16_bf16 v[56:71], v[128:131], a[84:87], v[56:71]
ds_read_b128 v[120:123], v2 offset:28672
buffer_load_dwordx4 v1, s[4:7], s39 offen offset:2048 lds
v_mfma_f32_32x32x16_bf16 v[72:87], v[132:135], a[84:87], v[72:87]
ds_read_b128 v[124:127], v2 offset:29696
s_waitcnt vmcnt(23) lgkmcnt(4)
v_mfma_f32_32x32x16_bf16 v[24:39], v[104:107], a[88:91], v[24:39]
ds_read_b128 v[128:131], v2 offset:30720
buffer_load_dwordx4 v1, s[4:7], s39 offen offset:3072 lds
v_mfma_f32_32x32x16_bf16 v[40:55], v[108:111], a[88:91], v[40:55]
ds_read_b128 v[132:135], v2 offset:31744
s_waitcnt lgkmcnt(4)
v_mfma_f32_32x32x16_bf16 v[56:71], v[112:115], a[88:91], v[56:71]
ds_read_b128 v[104:107], v2 offset:32768
v_mfma_f32_32x32x16_bf16 v[72:87], v[116:119], a[88:91], v[72:87]
ds_read_b128 v[108:111], v2 offset:33792
s_add_u32 s39, s13, 3870720
s_add_u32 m0, s14, 4096
s_nop 0
buffer_load_dwordx4 v1, s[4:7], s39 offen offset:0 lds
s_waitcnt lgkmcnt(4)
v_mfma_f32_32x32x16_bf16 v[24:39], v[120:123], a[92:95], v[24:39]
ds_read_b128 v[112:115], v2 offset:36864
v_mfma_f32_32x32x16_bf16 v[40:55], v[124:127], a[92:95], v[40:55]
ds_read_b128 v[116:119], v2 offset:37888
buffer_load_dwordx4 v1, s[4:7], s39 offen offset:1024 lds
s_waitcnt lgkmcnt(4)
v_mfma_f32_32x32x16_bf16 v[56:71], v[128:131], a[92:95], v[56:71]
ds_read_b128 v[120:123], v2 offset:40960
v_mfma_f32_32x32x16_bf16 v[72:87], v[132:135], a[92:95], v[72:87]
ds_read_b128 v[124:127], v2 offset:41984
buffer_load_dwordx4 v1, s[4:7], s39 offen offset:2048 lds
s_waitcnt vmcnt(25) lgkmcnt(4)
v_mfma_f32_32x32x16_bf16 v[24:39], v[104:107], a[96:99], v[24:39]
ds_read_b128 v[128:131], v2 offset:45056
v_mfma_f32_32x32x16_bf16 v[40:55], v[108:111], a[96:99], v[40:55]
ds_read_b128 v[132:135], v2 offset:46080
buffer_load_dwordx4 v1, s[4:7], s39 offen offset:3072 lds
s_waitcnt lgkmcnt(4)
v_mfma_f32_32x32x16_bf16 v[24:39], v[112:115], a[100:103], v[24:39]
ds_read_b128 v[104:107], v2 offset:49152
v_mfma_f32_32x32x16_bf16 v[40:55], v[116:119], a[100:103], v[40:55]
ds_read_b128 v[108:111], v2 offset:50176
s_add_u32 s39, s13, 3874816
s_add_u32 m0, s14, 8192
s_nop 0
buffer_load_dwordx4 v1, s[4:7], s39 offen offset:0 lds
s_waitcnt vmcnt(25) lgkmcnt(4)
v_mfma_f32_32x32x16_bf16 v[24:39], v[120:123], a[104:107], v[24:39]
ds_read_b128 v[112:115], v2 offset:53248
v_mfma_f32_32x32x16_bf16 v[40:55], v[124:127], a[104:107], v[40:55]
ds_read_b128 v[116:119], v2 offset:54272
s_waitcnt lgkmcnt(4)
v_mfma_f32_32x32x16_bf16 v[24:39], v[128:131], a[108:111], v[24:39]
ds_read_b128 v[120:123], v2 offset:57344
buffer_load_dwordx4 v1, s[4:7], s39 offen offset:1024 lds
v_mfma_f32_32x32x16_bf16 v[40:55], v[132:135], a[108:111], v[40:55]
ds_read_b128 v[124:127], v2 offset:58368
s_waitcnt vmcnt(24) lgkmcnt(4)
v_mfma_f32_32x32x16_bf16 v[24:39], v[104:107], a[112:115], v[24:39]
ds_read_b128 v[128:131], v2 offset:61440
s_add_u32 s97, s99, 8409088
buffer_load_dwordx4 v[180:183], v1, s[4:7], s97 offen offset:0
v_mfma_f32_32x32x16_bf16 v[40:55], v[108:111], a[112:115], v[40:55]
ds_read_b128 v[132:135], v2 offset:62464
s_waitcnt lgkmcnt(4)
v_mfma_f32_32x32x16_bf16 v[24:39], v[112:115], a[116:119], v[24:39]
ds_read_b128 v[104:107], v3 offset:0
buffer_load_dwordx4 v[184:187], v1, s[4:7], s97 offen offset:1024
v_mfma_f32_32x32x16_bf16 v[40:55], v[116:119], a[116:119], v[40:55]
ds_read_b128 v[108:111], v3 offset:1024
s_waitcnt vmcnt(24) lgkmcnt(4)
v_mfma_f32_32x32x16_bf16 v[24:39], v[120:123], a[120:123], v[24:39]
ds_read_b128 v[112:115], v3 offset:4096
buffer_load_dwordx4 v[188:191], v1, s[4:7], s97 offen offset:2048
v_mfma_f32_32x32x16_bf16 v[40:55], v[124:127], a[120:123], v[40:55]
ds_read_b128 v[116:119], v3 offset:5120
s_waitcnt lgkmcnt(4)
v_mfma_f32_32x32x16_bf16 v[24:39], v[128:131], a[124:127], v[24:39]
ds_read_b128 v[120:123], v3 offset:8192
v_mfma_f32_32x32x16_bf16 v[40:55], v[132:135], a[124:127], v[40:55]
ds_read_b128 v[124:127], v3 offset:9216
buffer_load_dwordx4 v[192:195], v1, s[4:7], s97 offen offset:3072
s_waitcnt vmcnt(24) lgkmcnt(4)
v_mfma_f32_32x32x16_bf16 v[24:39], v[104:107], a[128:131], v[24:39]
ds_read_b128 v[128:131], v3 offset:12288
v_mfma_f32_32x32x16_bf16 v[40:55], v[108:111], a[128:131], v[40:55]
ds_read_b128 v[132:135], v3 offset:13312
s_add_u32 s97, s99, 8413184
buffer_load_dwordx4 v[196:199], v1, s[4:7], s97 offen offset:0
s_waitcnt lgkmcnt(4)
v_mfma_f32_32x32x16_bf16 v[24:39], v[112:115], a[132:135], v[24:39]
ds_read_b128 v[104:107], v3 offset:16384
v_mfma_f32_32x32x16_bf16 v[40:55], v[116:119], a[132:135], v[40:55]
ds_read_b128 v[108:111], v3 offset:17408
s_add_u32 s97, s99, 8435712
buffer_load_dwordx4 a[216:219], v1, s[4:7], s97 offen offset:0
s_waitcnt vmcnt(24) lgkmcnt(4)
v_mfma_f32_32x32x16_bf16 v[24:39], v[120:123], a[136:139], v[24:39]
ds_read_b128 v[112:115], v3 offset:20480
v_mfma_f32_32x32x16_bf16 v[40:55], v[124:127], a[136:139], v[40:55]
ds_read_b128 v[116:119], v3 offset:21504
buffer_load_dwordx4 a[220:223], v1, s[4:7], s97 offen offset:1024
s_waitcnt lgkmcnt(4)
v_mfma_f32_32x32x16_bf16 v[24:39], v[128:131], a[140:143], v[24:39]
ds_read_b128 v[120:123], v3 offset:24576
v_mfma_f32_32x32x16_bf16 v[40:55], v[132:135], a[140:143], v[40:55]
ds_read_b128 v[124:127], v3 offset:25600
buffer_load_dwordx4 a[224:227], v1, s[4:7], s97 offen offset:2048
s_waitcnt vmcnt(24) lgkmcnt(4)
v_mfma_f32_32x32x16_bf16 v[24:39], v[104:107], a[144:147], v[24:39]
ds_read_b128 v[128:131], v3 offset:28672
v_mfma_f32_32x32x16_bf16 v[40:55], v[108:111], a[144:147], v[40:55]
ds_read_b128 v[132:135], v3 offset:29696
s_waitcnt lgkmcnt(4)
v_mfma_f32_32x32x16_bf16 v[24:39], v[112:115], a[148:151], v[24:39]
ds_read_b128 v[104:107], v2 offset:34816
s_add_u32 s39, s13, 3907584
s_add_u32 m0, s14, 40960
s_nop 0
buffer_load_dwordx4 v1, s[4:7], s39 offen offset:0 lds
v_mfma_f32_32x32x16_bf16 v[40:55], v[116:119], a[148:151], v[40:55]
ds_read_b128 v[108:111], v2 offset:35840
s_waitcnt vmcnt(23) lgkmcnt(4)
v_mfma_f32_32x32x16_bf16 v[24:39], v[120:123], a[152:155], v[24:39]
ds_read_b128 v[112:115], v2 offset:38912
buffer_load_dwordx4 v1, s[4:7], s39 offen offset:1024 lds
v_mfma_f32_32x32x16_bf16 v[40:55], v[124:127], a[152:155], v[40:55]
ds_read_b128 v[116:119], v2 offset:39936
s_waitcnt lgkmcnt(4)
v_mfma_f32_32x32x16_bf16 v[24:39], v[128:131], a[156:159], v[24:39]
ds_read_b128 v[120:123], v2 offset:43008
buffer_load_dwordx4 v1, s[4:7], s39 offen offset:2048 lds
v_mfma_f32_32x32x16_bf16 v[40:55], v[132:135], a[156:159], v[40:55]
ds_read_b128 v[124:127], v2 offset:44032
v_mfma_f32_32x32x16_bf16 v[24:39], a[160:163], v[144:147], v[24:39]
v_mfma_f32_32x32x16_bf16 v[40:55], a[164:167], v[144:147], v[40:55]
s_waitcnt lgkmcnt(4)
v_mfma_f32_32x32x16_bf16 v[56:71], v[104:107], a[96:99], v[56:71]
ds_read_b128 v[128:131], v2 offset:47104
buffer_load_dwordx4 v1, s[4:7], s39 offen offset:3072 lds
v_mfma_f32_32x32x16_bf16 v[72:87], v[108:111], a[96:99], v[72:87]
ds_read_b128 v[132:135], v2 offset:48128
s_waitcnt lgkmcnt(4)
v_mfma_f32_32x32x16_bf16 v[56:71], v[112:115], a[100:103], v[56:71]
ds_read_b128 v[104:107], v2 offset:51200
s_nop 3
v_mul_f32 v24, v24, v148
v_mul_f32 v25, v25, v148
v_mul_f32 v26, v26, v148
v_mul_f32 v27, v27, v148
v_mfma_f32_32x32x16_bf16 v[72:87], v[116:119], a[100:103], v[72:87]
ds_read_b128 v[108:111], v2 offset:52224
s_add_u32 s39, s13, 3911680
s_add_u32 m0, s14, 45056
s_nop 0
buffer_load_dwordx4 v1, s[4:7], s39 offen offset:0 lds
v_exp_f32 v24, v24
s_waitcnt lgkmcnt(4)
v_mfma_f32_32x32x16_bf16 v[56:71], v[120:123], a[104:107], v[56:71]
ds_read_b128 v[112:115], v2 offset:55296
v_exp_f32 v25, v25
v_exp_f32 v26, v26
v_mfma_f32_32x32x16_bf16 v[72:87], v[124:127], a[104:107], v[72:87]
ds_read_b128 v[116:119], v2 offset:56320
buffer_load_dwordx4 v1, s[4:7], s39 offen offset:1024 lds
v_exp_f32 v27, v27
v_fma_f32 v24, v24, v150, v150
v_fma_f32 v25, v25, v150, v150
s_waitcnt lgkmcnt(4)
v_mfma_f32_32x32x16_bf16 v[56:71], v[128:131], a[108:111], v[56:71]
ds_read_b128 v[120:123], v2 offset:59392
v_fma_f32 v26, v26, v150, v150
v_fma_f32 v27, v27, v150, v150
v_rcp_f32 v24, v24
v_mfma_f32_32x32x16_bf16 v[72:87], v[132:135], a[108:111], v[72:87]
ds_read_b128 v[124:127], v2 offset:60416
buffer_load_dwordx4 v1, s[4:7], s39 offen offset:2048 lds
v_rcp_f32 v25, v25
v_rcp_f32 v26, v26
s_waitcnt lgkmcnt(4)
v_mfma_f32_32x32x16_bf16 v[56:71], v[104:107], a[112:115], v[56:71]
ds_read_b128 v[128:131], v2 offset:63488
v_rcp_f32 v27, v27
v_mul_f32 v24, v24, v32
v_mul_f32 v25, v25, v33
v_mul_f32 v26, v26, v34
v_mfma_f32_32x32x16_bf16 v[72:87], v[108:111], a[112:115], v[72:87]
ds_read_b128 v[132:135], v2 offset:64512
buffer_load_dwordx4 v1, s[4:7], s39 offen offset:3072 lds
v_mul_f32 v27, v27, v35
v_cvt_pk_bf16_f32 v156, v24, v25
s_waitcnt lgkmcnt(4)
v_mfma_f32_32x32x16_bf16 v[56:71], v[112:115], a[116:119], v[56:71]
ds_read_b128 v[104:107], v3 offset:2048
v_cvt_pk_bf16_f32 v157, v26, v27
v_mul_f32 v28, v28, v148
v_mul_f32 v29, v29, v148
v_mul_f32 v30, v30, v148
v_mul_f32 v31, v31, v148
v_mfma_f32_32x32x16_bf16 v[72:87], v[116:119], a[116:119], v[72:87]
ds_read_b128 v[108:111], v3 offset:3072
s_add_u32 s39, s13, 3915776
s_add_u32 m0, s14, 49152
s_nop 0
buffer_load_dwordx4 v1, s[4:7], s39 offen offset:0 lds
s_waitcnt lgkmcnt(4)
v_mfma_f32_32x32x16_bf16 v[56:71], v[120:123], a[120:123], v[56:71]
ds_read_b128 v[112:115], v3 offset:6144
v_exp_f32 v28, v28
v_exp_f32 v29, v29
v_mfma_f32_32x32x16_bf16 v[72:87], v[124:127], a[120:123], v[72:87]
ds_read_b128 v[116:119], v3 offset:7168
v_exp_f32 v30, v30
v_exp_f32 v31, v31
v_fma_f32 v28, v28, v150, v150
s_waitcnt lgkmcnt(4)
v_mfma_f32_32x32x16_bf16 v[56:71], v[128:131], a[124:127], v[56:71]
ds_read_b128 v[120:123], v3 offset:10240
buffer_load_dwordx4 v1, s[4:7], s39 offen offset:1024 lds
v_fma_f32 v29, v29, v150, v150
v_fma_f32 v30, v30, v150, v150
v_fma_f32 v31, v31, v150, v150
v_mfma_f32_32x32x16_bf16 v[72:87], v[132:135], a[124:127], v[72:87]
ds_read_b128 v[124:127], v3 offset:11264
v_rcp_f32 v28, v28
v_rcp_f32 v29, v29
s_waitcnt lgkmcnt(4)
v_mfma_f32_32x32x16_bf16 v[56:71], v[104:107], a[128:131], v[56:71]
ds_read_b128 v[128:131], v3 offset:14336
v_rcp_f32 v30, v30
v_rcp_f32 v31, v31
v_mul_f32 v28, v28, v36
v_mfma_f32_32x32x16_bf16 v[72:87], v[108:111], a[128:131], v[72:87]
ds_read_b128 v[132:135], v3 offset:15360
v_mul_f32 v29, v29, v37
v_mul_f32 v30, v30, v38
v_mul_f32 v31, v31, v39
v_cvt_pk_bf16_f32 v158, v28, v29
s_waitcnt lgkmcnt(4)
v_mfma_f32_32x32x16_bf16 v[56:71], v[112:115], a[132:135], v[56:71]
ds_read_b128 v[104:107], v3 offset:18432
v_cvt_pk_bf16_f32 v159, v30, v31
buffer_store_dwordx4 v[156:159], v15, s[4:7], s12 offen offset:0 sc1
v_mul_f32 v40, v40, v148
v_mul_f32 v41, v41, v148
v_mul_f32 v42, v42, v148
v_mfma_f32_32x32x16_bf16 v[72:87], v[116:119], a[132:135], v[72:87]
ds_read_b128 v[108:111], v3 offset:19456
v_mul_f32 v43, v43, v148
v_exp_f32 v40, v40
s_waitcnt lgkmcnt(4)
v_mfma_f32_32x32x16_bf16 v[56:71], v[120:123], a[136:139], v[56:71]
ds_read_b128 v[112:115], v3 offset:22528
v_exp_f32 v41, v41
v_exp_f32 v42, v42
v_mfma_f32_32x32x16_bf16 v[72:87], v[124:127], a[136:139], v[72:87]
ds_read_b128 v[116:119], v3 offset:23552
v_exp_f32 v43, v43
v_fma_f32 v40, v40, v150, v150
v_fma_f32 v41, v41, v150, v150
v_fma_f32 v42, v42, v150, v150
s_waitcnt lgkmcnt(4)
v_mfma_f32_32x32x16_bf16 v[56:71], v[128:131], a[140:143], v[56:71]
ds_read_b128 v[120:123], v3 offset:26624
v_fma_f32 v43, v43, v150, v150
v_rcp_f32 v40, v40
v_rcp_f32 v41, v41
v_mfma_f32_32x32x16_bf16 v[72:87], v[132:135], a[140:143], v[72:87]
ds_read_b128 v[124:127], v3 offset:27648
v_rcp_f32 v42, v42
v_rcp_f32 v43, v43
s_waitcnt lgkmcnt(4)
v_mfma_f32_32x32x16_bf16 v[56:71], v[104:107], a[144:147], v[56:71]
ds_read_b128 v[128:131], v3 offset:30720
v_mul_f32 v40, v40, v48
v_mul_f32 v41, v41, v49
v_mul_f32 v42, v42, v50
v_mul_f32 v43, v43, v51
v_mfma_f32_32x32x16_bf16 v[72:87], v[108:111], a[144:147], v[72:87]
ds_read_b128 v[132:135], v3 offset:31744
v_cvt_pk_bf16_f32 v160, v40, v41
v_cvt_pk_bf16_f32 v161, v42, v43
v_mul_f32 v44, v44, v148
v_mul_f32 v45, v45, v148
v_mul_f32 v46, v46, v148
s_waitcnt vmcnt(19)
s_barrier
s_waitcnt lgkmcnt(4)
v_mfma_f32_32x32x16_bf16 v[56:71], v[112:115], a[148:151], v[56:71]
ds_read_b128 v[104:107], v1 offset:0
s_add_u32 s39, s13, 3948544
s_add_u32 m0, s14, 122880
s_nop 0
buffer_load_dwordx4 v1, s[4:7], s39 offen offset:0 lds
v_mfma_f32_32x32x16_bf16 v[72:87], v[116:119], a[148:151], v[72:87]
ds_read_b128 v[108:111], v1 offset:1024
v_mul_f32 v47, v47, v148
v_exp_f32 v44, v44
s_waitcnt lgkmcnt(4)
v_mfma_f32_32x32x16_bf16 v[56:71], v[120:123], a[152:155], v[56:71]
ds_read_b128 v[112:115], v1 offset:2048
buffer_load_dwordx4 v1, s[4:7], s39 offen offset:1024 lds
v_exp_f32 v45, v45
v_exp_f32 v46, v46
v_mfma_f32_32x32x16_bf16 v[72:87], v[124:127], a[152:155], v[72:87]
ds_read_b128 v[116:119], v1 offset:3072
v_exp_f32 v47, v47
v_fma_f32 v44, v44, v150, v150
v_fma_f32 v45, v45, v150, v150
s_waitcnt lgkmcnt(4)
v_mfma_f32_32x32x16_bf16 v[56:71], v[128:131], a[156:159], v[56:71]
ds_read_b128 v[120:123], v1 offset:4096
buffer_load_dwordx4 v1, s[4:7], s39 offen offset:2048 lds
v_fma_f32 v46, v46, v150, v150
v_fma_f32 v47, v47, v150, v150
v_rcp_f32 v44, v44
v_mfma_f32_32x32x16_bf16 v[72:87], v[132:135], a[156:159], v[72:87]
ds_read_b128 v[124:127], v1 offset:5120
v_mfma_f32_32x32x16_bf16 v[56:71], a[168:171], v[144:147], v[56:71]
v_mfma_f32_32x32x16_bf16 v[72:87], a[172:175], v[144:147], v[72:87]
s_waitcnt lgkmcnt(4)
v_mfma_f32_32x32x16_bf16 v[88:103], v[104:107], a[0:3], 0
ds_read_b128 v[128:131], v1 offset:6144
buffer_load_dwordx4 v1, s[4:7], s39 offen offset:3072 lds
v_rcp_f32 v45, v45
v_rcp_f32 v46, v46
v_mfma_f32_32x32x16_bf16 v[88:103], v[108:111], a[4:7], v[88:103]
ds_read_b128 v[132:135], v1 offset:7168
v_rcp_f32 v47, v47
v_mul_f32 v44, v44, v52
v_mul_f32 v45, v45, v53
s_waitcnt lgkmcnt(4)
v_mfma_f32_32x32x16_bf16 v[88:103], v[112:115], a[8:11], v[88:103]
ds_read_b128 v[104:107], v1 offset:8192
v_mul_f32 v46, v46, v54
v_mul_f32 v47, v47, v55
v_cvt_pk_bf16_f32 v162, v44, v45
v_cvt_pk_bf16_f32 v163, v46, v47
v_mfma_f32_32x32x16_bf16 v[88:103], v[116:119], a[12:15], v[88:103]
ds_read_b128 v[108:111], v1 offset:9216
s_add_u32 s39, s13, 3952640
s_add_u32 m0, s14, 126976
s_nop 0
buffer_load_dwordx4 v1, s[4:7], s39 offen offset:0 lds
buffer_store_dwordx4 v[160:163], v15, s[4:7], s12 offen offset:512 sc1
v_mul_f32 v56, v56, v148
s_waitcnt lgkmcnt(4)
v_mfma_f32_32x32x16_bf16 v[88:103], v[120:123], a[16:19], v[88:103]
ds_read_b128 v[112:115], v1 offset:10240
v_mul_f32 v57, v57, v148
v_mul_f32 v58, v58, v148
v_mul_f32 v59, v59, v148
v_mfma_f32_32x32x16_bf16 v[88:103], v[124:127], a[20:23], v[88:103]
ds_read_b128 v[116:119], v1 offset:11264
buffer_load_dwordx4 v1, s[4:7], s39 offen offset:1024 lds
v_exp_f32 v56, v56
v_exp_f32 v57, v57
s_waitcnt lgkmcnt(4)
v_mfma_f32_32x32x16_bf16 v[88:103], v[128:131], a[24:27], v[88:103]
ds_read_b128 v[120:123], v1 offset:12288
v_exp_f32 v58, v58
v_exp_f32 v59, v59
v_fma_f32 v56, v56, v150, v150
v_mfma_f32_32x32x16_bf16 v[88:103], v[132:135], a[28:31], v[88:103]
ds_read_b128 v[124:127], v1 offset:13312
v_fma_f32 v57, v57, v150, v150
v_fma_f32 v58, v58, v150, v150
v_fma_f32 v59, v59, v150, v150
v_rcp_f32 v56, v56
s_waitcnt lgkmcnt(4)
v_mfma_f32_32x32x16_bf16 v[88:103], v[104:107], a[32:35], v[88:103]
ds_read_b128 v[128:131], v1 offset:14336
buffer_load_dwordx4 v1, s[4:7], s39 offen offset:2048 lds
v_rcp_f32 v57, v57
v_mfma_f32_32x32x16_bf16 v[88:103], v[108:111], a[36:39], v[88:103]
ds_read_b128 v[132:135], v1 offset:15360
v_rcp_f32 v58, v58
v_rcp_f32 v59, v59
v_mul_f32 v56, v56, v64
v_mul_f32 v57, v57, v65
s_waitcnt lgkmcnt(4)
v_mfma_f32_32x32x16_bf16 v[88:103], v[112:115], a[40:43], v[88:103]
ds_read_b128 v[104:107], v1 offset:16384
buffer_load_dwordx4 v1, s[4:7], s39 offen offset:3072 lds
v_mul_f32 v58, v58, v66
v_mul_f32 v59, v59, v67
v_cvt_pk_bf16_f32 v156, v56, v57
v_mfma_f32_32x32x16_bf16 v[88:103], v[116:119], a[44:47], v[88:103]
ds_read_b128 v[108:111], v1 offset:17408
v_cvt_pk_bf16_f32 v157, v58, v59
v_mul_f32 v60, v60, v148
v_mul_f32 v61, v61, v148
v_mul_f32 v62, v62, v148
s_waitcnt lgkmcnt(4)
v_mfma_f32_32x32x16_bf16 v[88:103], v[120:123], a[48:51], v[88:103]
ds_read_b128 v[112:115], v1 offset:18432
v_mul_f32 v63, v63, v148
v_exp_f32 v60, v60
v_exp_f32 v61, v61
v_mfma_f32_32x32x16_bf16 v[88:103], v[124:127], a[52:55], v[88:103]
ds_read_b128 v[116:119], v1 offset:19456
s_add_u32 s39, s13, 3956736
s_add_u32 m0, s14, 131072
s_nop 0
buffer_load_dwordx4 v1, s[4:7], s39 offen offset:0 lds
s_waitcnt lgkmcnt(4)
v_mfma_f32_32x32x16_bf16 v[88:103], v[128:131], a[56:59], v[88:103]
ds_read_b128 v[120:123], v1 offset:20480
v_exp_f32 v62, v62
v_exp_f32 v63, v63
v_fma_f32 v60, v60, v150, v150
v_fma_f32 v61, v61, v150, v150
v_mfma_f32_32x32x16_bf16 v[88:103], v[132:135], a[60:63], v[88:103]
ds_read_b128 v[124:127], v1 offset:21504
buffer_load_dwordx4 v1, s[4:7], s39 offen offset:1024 lds
v_fma_f32 v62, v62, v150, v150
v_fma_f32 v63, v63, v150, v150
s_waitcnt lgkmcnt(4)
v_mfma_f32_32x32x16_bf16 v[88:103], v[104:107], a[64:67], v[88:103]
ds_read_b128 v[128:131], v1 offset:22528
v_rcp_f32 v60, v60
v_rcp_f32 v61, v61
v_rcp_f32 v62, v62
v_mfma_f32_32x32x16_bf16 v[88:103], v[108:111], a[68:71], v[88:103]
ds_read_b128 v[132:135], v1 offset:23552
v_rcp_f32 v63, v63
v_mul_f32 v60, v60, v68
v_mul_f32 v61, v61, v69
s_waitcnt lgkmcnt(4)
v_mfma_f32_32x32x16_bf16 v[88:103], v[112:115], a[72:75], v[88:103]
ds_read_b128 v[104:107], v1 offset:24576
s_add_u32 s97, s99, 8438784
buffer_load_dwordx4 a[228:231], v1, s[4:7], s97 offen offset:0
v_mul_f32 v62, v62, v70
v_mul_f32 v63, v63, v71
v_mfma_f32_32x32x16_bf16 v[88:103], v[116:119], a[76:79], v[88:103]
ds_read_b128 v[108:111], v1 offset:25600
v_cvt_pk_bf16_f32 v158, v60, v61
v_cvt_pk_bf16_f32 v159, v62, v63
buffer_store_dwordx4 v[156:159], v15, s[4:7], s12 offen offset:1024 sc1
v_mul_f32 v72, v72, v148
v_mul_f32 v73, v73, v148
s_waitcnt lgkmcnt(4)
v_mfma_f32_32x32x16_bf16 v[88:103], v[120:123], a[80:83], v[88:103]
ds_read_b128 v[112:115], v1 offset:26624
buffer_load_dwordx4 a[232:235], v1, s[4:7], s97 offen offset:1024
v_mul_f32 v74, v74, v148
v_mul_f32 v75, v75, v148
v_mfma_f32_32x32x16_bf16 v[88:103], v[124:127], a[84:87], v[88:103]
ds_read_b128 v[116:119], v1 offset:27648
v_exp_f32 v72, v72
v_exp_f32 v73, v73
v_exp_f32 v74, v74
s_waitcnt lgkmcnt(4)
v_mfma_f32_32x32x16_bf16 v[88:103], v[128:131], a[88:91], v[88:103]
ds_read_b128 v[120:123], v1 offset:28672
v_exp_f32 v75, v75
v_fma_f32 v72, v72, v150, v150
v_fma_f32 v73, v73, v150, v150
v_mfma_f32_32x32x16_bf16 v[88:103], v[132:135], a[92:95], v[88:103]
ds_read_b128 v[124:127], v1 offset:29696
buffer_load_dwordx4 a[236:239], v1, s[4:7], s97 offen offset:2048
v_fma_f32 v74, v74, v150, v150
v_fma_f32 v75, v75, v150, v150
v_rcp_f32 v72, v72
s_waitcnt lgkmcnt(4)
v_mfma_f32_32x32x16_bf16 v[88:103], v[104:107], a[96:99], v[88:103]
ds_read_b128 v[128:131], v1 offset:30720
v_rcp_f32 v73, v73
v_rcp_f32 v74, v74
v_mfma_f32_32x32x16_bf16 v[88:103], v[108:111], a[100:103], v[88:103]
ds_read_b128 v[132:135], v1 offset:31744
buffer_load_dwordx4 a[240:243], v1, s[4:7], s97 offen offset:3072
v_rcp_f32 v75, v75
v_mul_f32 v72, v72, v80
v_mul_f32 v73, v73, v81
s_waitcnt lgkmcnt(4)
v_mfma_f32_32x32x16_bf16 v[88:103], v[112:115], a[104:107], v[88:103]
ds_read_b128 v[104:107], v1 offset:32768
v_mul_f32 v74, v74, v82
v_mul_f32 v75, v75, v83
v_cvt_pk_bf16_f32 v160, v72, v73
v_cvt_pk_bf16_f32 v161, v74, v75
v_mfma_f32_32x32x16_bf16 v[88:103], v[116:119], a[108:111], v[88:103]
ds_read_b128 v[108:111], v1 offset:33792
v_mul_f32 v76, v76, v148
v_mul_f32 v77, v77, v148
v_mul_f32 v78, v78, v148
v_mul_f32 v79, v79, v148
s_waitcnt lgkmcnt(4)
v_mfma_f32_32x32x16_bf16 v[88:103], v[120:123], a[112:115], v[88:103]
ds_read_b128 v[112:115], v1 offset:34816
s_add_u32 s97, s99, 8442880
buffer_load_dwordx4 a[244:247], v1, s[4:7], s97 offen offset:0
v_exp_f32 v76, v76
v_mfma_f32_32x32x16_bf16 v[88:103], v[124:127], a[116:119], v[88:103]
ds_read_b128 v[116:119], v1 offset:35840
v_exp_f32 v77, v77
v_exp_f32 v78, v78
s_waitcnt lgkmcnt(4)
v_mfma_f32_32x32x16_bf16 v[88:103], v[128:131], a[120:123], v[88:103]
ds_read_b128 v[120:123], v1 offset:36864
buffer_load_dwordx4 a[248:251], v1, s[4:7], s97 offen offset:1024
v_exp_f32 v79, v79
v_fma_f32 v76, v76, v150, v150
v_fma_f32 v77, v77, v150, v150
v_fma_f32 v78, v78, v150, v150
v_mfma_f32_32x32x16_bf16 v[88:103], v[132:135], a[124:127], v[88:103]
ds_read_b128 v[124:127], v1 offset:37888
v_fma_f32 v79, v79, v150, v150
v_rcp_f32 v76, v76
s_waitcnt lgkmcnt(4)
v_mfma_f32_32x32x16_bf16 v[88:103], v[104:107], a[128:131], v[88:103]
ds_read_b128 v[128:131], v1 offset:38912
v_rcp_f32 v77, v77
v_rcp_f32 v78, v78
v_rcp_f32 v79, v79
v_mfma_f32_32x32x16_bf16 v[88:103], v[108:111], a[132:135], v[88:103]
ds_read_b128 v[132:135], v1 offset:39936
buffer_load_dwordx4 a[252:255], v1, s[4:7], s97 offen offset:2048
v_mul_f32 v76, v76, v84
v_mul_f32 v77, v77, v85
v_mul_f32 v78, v78, v86
s_waitcnt vmcnt(20)
s_barrier
s_waitcnt lgkmcnt(4)
v_mfma_f32_32x32x16_bf16 v[88:103], v[112:115], a[136:139], v[88:103]
ds_read_b128 v[104:107], v1 offset:40960
v_mul_f32 v79, v79, v87
v_cvt_pk_bf16_f32 v162, v76, v77
v_mfma_f32_32x32x16_bf16 v[88:103], v[116:119], a[140:143], v[88:103]
ds_read_b128 v[108:111], v1 offset:41984
s_add_u32 s39, s3, 8425472
s_add_u32 m0, s59, 81920
s_nop 0
buffer_load_dwordx4 v1, s[4:7], s39 offen offset:0 lds
v_cvt_pk_bf16_f32 v163, v78, v79
buffer_store_dwordx4 v[160:163], v15, s[4:7], s96 offen offset:0 sc1
s_waitcnt lgkmcnt(4)
v_mfma_f32_32x32x16_bf16 v[88:103], v[120:123], a[144:147], v[88:103]
ds_read_b128 v[112:115], v1 offset:43008
v_mfma_f32_32x32x16_bf16 v[88:103], v[124:127], a[148:151], v[88:103]
ds_read_b128 v[116:119], v1 offset:44032
s_waitcnt lgkmcnt(4)
v_mfma_f32_32x32x16_bf16 v[88:103], v[128:131], a[152:155], v[88:103]
ds_read_b128 v[120:123], v1 offset:45056
buffer_load_dwordx4 v1, s[4:7], s39 offen offset:1024 lds
v_mfma_f32_32x32x16_bf16 v[88:103], v[132:135], a[156:159], v[88:103]
ds_read_b128 v[124:127], v1 offset:46080
v_mfma_f32_32x32x16_bf16 v[88:103], a[176:179], v[144:147], v[88:103]
s_waitcnt lgkmcnt(4)
v_mfma_f32_32x32x16_bf16 v[24:39], v[104:107], a[0:3], 0
ds_read_b128 v[128:131], v1 offset:47104
buffer_load_dwordx4 v1, s[4:7], s39 offen offset:2048 lds
v_mfma_f32_32x32x16_bf16 v[24:39], v[108:111], a[4:7], v[24:39]
ds_read_b128 v[132:135], v1 offset:48128
s_waitcnt lgkmcnt(4)
v_mfma_f32_32x32x16_bf16 v[24:39], v[112:115], a[8:11], v[24:39]
ds_read_b128 v[104:107], v1 offset:49152
v_mfma_f32_32x32x16_bf16 v[24:39], v[116:119], a[12:15], v[24:39]
ds_read_b128 v[108:111], v1 offset:50176
buffer_load_dwordx4 v1, s[4:7], s39 offen offset:3072 lds
s_nop 1
v_mul_f32 v88, v88, v148
v_mul_f32 v89, v89, v148
v_mul_f32 v90, v90, v148
v_mul_f32 v91, v91, v148
s_waitcnt lgkmcnt(4)
v_mfma_f32_32x32x16_bf16 v[24:39], v[120:123], a[16:19], v[24:39]
ds_read_b128 v[112:115], v1 offset:51200
v_exp_f32 v88, v88
v_exp_f32 v89, v89
v_mfma_f32_32x32x16_bf16 v[24:39], v[124:127], a[20:23], v[24:39]
ds_read_b128 v[116:119], v1 offset:52224
s_add_u32 s39, s3, 8429568
s_add_u32 m0, s59, 86016
s_nop 0
buffer_load_dwordx4 v1, s[4:7], s39 offen offset:0 lds
v_exp_f32 v90, v90
s_waitcnt lgkmcnt(4)
v_mfma_f32_32x32x16_bf16 v[24:39], v[128:131], a[24:27], v[24:39]
ds_read_b128 v[120:123], v1 offset:53248
v_exp_f32 v91, v91
v_fma_f32 v88, v88, v150, v150
v_fma_f32 v89, v89, v150, v150
v_fma_f32 v90, v90, v150, v150
v_mfma_f32_32x32x16_bf16 v[24:39], v[132:135], a[28:31], v[24:39]
ds_read_b128 v[124:127], v1 offset:54272
v_fma_f32 v91, v91, v150, v150
v_rcp_f32 v88, v88
v_rcp_f32 v89, v89
s_waitcnt lgkmcnt(4)
v_mfma_f32_32x32x16_bf16 v[24:39], v[104:107], a[32:35], v[24:39]
ds_read_b128 v[128:131], v1 offset:55296
s_add_u32 s39, s3, 8404992
s_add_u32 m0, s59, 0
s_nop 0
buffer_load_dwordx4 v1, s[4:7], s39 offen offset:0 lds
v_mfma_f32_32x32x16_bf16 v[24:39], v[108:111], a[36:39], v[24:39]
ds_read_b128 v[132:135], v1 offset:56320
v_rcp_f32 v90, v90
v_rcp_f32 v91, v91
v_mul_f32 v88, v88, v96
v_mul_f32 v89, v89, v97
s_waitcnt lgkmcnt(4)
v_mfma_f32_32x32x16_bf16 v[24:39], v[112:115], a[40:43], v[24:39]
ds_read_b128 v[104:107], v1 offset:57344
buffer_load_dwordx4 v1, s[4:7], s39 offen offset:1024 lds
v_mul_f32 v90, v90, v98
v_mul_f32 v91, v91, v99
v_cvt_pk_bf16_f32 v156, v88, v89
v_mfma_f32_32x32x16_bf16 v[24:39], v[116:119], a[44:47], v[24:39]
ds_read_b128 v[108:111], v1 offset:58368
v_cvt_pk_bf16_f32 v157, v90, v91
v_mul_f32 v92, v92, v148
v_mul_f32 v93, v93, v148
v_mul_f32 v94, v94, v148
s_waitcnt lgkmcnt(4)
v_mfma_f32_32x32x16_bf16 v[24:39], v[120:123], a[48:51], v[24:39]
ds_read_b128 v[112:115], v1 offset:59392
v_mul_f32 v95, v95, v148
v_exp_f32 v92, v92
v_exp_f32 v93, v93
v_mfma_f32_32x32x16_bf16 v[24:39], v[124:127], a[52:55], v[24:39]
ds_read_b128 v[116:119], v1 offset:60416
buffer_load_dwordx4 v1, s[4:7], s39 offen offset:2048 lds
v_exp_f32 v94, v94
s_waitcnt lgkmcnt(4)
v_mfma_f32_32x32x16_bf16 v[24:39], v[128:131], a[56:59], v[24:39]
ds_read_b128 v[120:123], v1 offset:61440
v_exp_f32 v95, v95
v_fma_f32 v92, v92, v150, v150
v_fma_f32 v93, v93, v150, v150
v_fma_f32 v94, v94, v150, v150
v_fma_f32 v95, v95, v150, v150
v_mfma_f32_32x32x16_bf16 v[24:39], v[132:135], a[60:63], v[24:39]
ds_read_b128 v[124:127], v1 offset:62464
buffer_load_dwordx4 v1, s[4:7], s39 offen offset:3072 lds
v_rcp_f32 v92, v92
s_waitcnt lgkmcnt(4)
v_mfma_f32_32x32x16_bf16 v[24:39], v[104:107], a[64:67], v[24:39]
ds_read_b128 v[128:131], v1 offset:63488
v_rcp_f32 v93, v93
v_rcp_f32 v94, v94
v_rcp_f32 v95, v95
v_mfma_f32_32x32x16_bf16 v[24:39], v[108:111], a[68:71], v[24:39]
ds_read_b128 v[132:135], v1 offset:64512
v_mul_f32 v92, v92, v100
v_mul_f32 v93, v93, v101
v_mul_f32 v94, v94, v102
v_mul_f32 v95, v95, v103
s_waitcnt lgkmcnt(4)
v_mfma_f32_32x32x16_bf16 v[24:39], v[112:115], a[72:75], v[24:39]
ds_read_b128 v[104:107], v2 offset:0
s_add_u32 s39, s3, 8409088
s_add_u32 m0, s59, 4096
s_nop 0
buffer_load_dwordx4 v1, s[4:7], s39 offen offset:0 lds
v_cvt_pk_bf16_f32 v158, v92, v93
v_mfma_f32_32x32x16_bf16 v[24:39], v[116:119], a[76:79], v[24:39]
ds_read_b128 v[108:111], v2 offset:1024
v_cvt_pk_bf16_f32 v159, v94, v95
buffer_store_dwordx4 v[156:159], v15, s[4:7], s15 offen offset:0 sc1
s_sub_u32 s100, s32, s16
s_mul_i32 s100, s100, 57344
s_add_u32 s100, s100, 26869760
s_waitcnt lgkmcnt(4)
v_mfma_f32_32x32x16_bf16 v[24:39], v[120:123], a[80:83], v[24:39]
ds_read_b128 v[112:115], v2 offset:2048
s_add_u32 s39, s3, 8410112
s_add_u32 m0, s59, 20480
s_nop 0
buffer_load_dwordx4 v1, s[4:7], s39 offen offset:0 lds
s_mul_i32 s34, s16, 8192
v_mfma_f32_32x32x16_bf16 v[24:39], v[124:127], a[84:87], v[24:39]
ds_read_b128 v[116:119], v2 offset:3072
s_add_u32 s100, s100, s34
s_mul_i32 s34, s19, 7340032
s_add_u32 s100, s100, s34
s_add_u32 s34, s16, 0
s_and_b32 s34, s34, 3
v_lshlrev_b32 v23, 8, v0
s_lshl_b32 s22, s17, 12
s_add_u32 s22, s22, s30
v_cndmask_b32 v23, v22, v23, s[40:41]
s_waitcnt vmcnt(11)
s_barrier
s_cmp_eq_u32 s16, 0
s_cbranch_scc0 L_if35
buffer_atomic_add v21, v23, s[4:7], s22 offen offset:12 sc1
L_if35:
s_waitcnt lgkmcnt(4)
v_mfma_f32_32x32x16_bf16 v[24:39], v[128:131], a[88:91], v[24:39]
ds_read_b128 v[120:123], v2 offset:4096
v_mfma_f32_32x32x16_bf16 v[24:39], v[132:135], a[92:95], v[24:39]
ds_read_b128 v[124:127], v2 offset:5120
buffer_load_dwordx4 v1, s[4:7], s39 offen offset:1024 lds
s_waitcnt lgkmcnt(4)
v_mfma_f32_32x32x16_bf16 v[24:39], v[104:107], a[96:99], v[24:39]
ds_read_b128 v[128:131], v2 offset:6144
s_mul_i32 s34, s34, 57344
s_add_u32 s34, s34, s100
s_add_u32 s35, s16, 1
s_and_b32 s35, s35, 3
v_mfma_f32_32x32x16_bf16 v[24:39], v[108:111], a[100:103], v[24:39]
ds_read_b128 v[132:135], v2 offset:7168
buffer_load_dwordx4 v1, s[4:7], s39 offen offset:2048 lds
s_mul_i32 s35, s35, 57344
s_add_u32 s35, s35, s100
s_add_u32 s36, s16, 2
s_and_b32 s36, s36, 3
s_waitcnt lgkmcnt(4)
v_mfma_f32_32x32x16_bf16 v[24:39], v[112:115], a[104:107], v[24:39]
ds_read_b128 v[104:107], v2 offset:8192
s_mul_i32 s36, s36, 57344
s_add_u32 s36, s36, s100
s_add_u32 s37, s16, 3
s_and_b32 s37, s37, 3
v_mfma_f32_32x32x16_bf16 v[24:39], v[116:119], a[108:111], v[24:39]
ds_read_b128 v[108:111], v2 offset:9216
s_mul_i32 s37, s37, 57344
s_add_u32 s37, s37, s100
s_waitcnt lgkmcnt(4)
v_mfma_f32_32x32x16_bf16 v[24:39], v[120:123], a[112:115], v[24:39]
ds_read_b128 v[112:115], v2 offset:10240
buffer_load_dwordx4 v1, s[4:7], s39 offen offset:3072 lds
v_mfma_f32_32x32x16_bf16 v[24:39], v[124:127], a[116:119], v[24:39]
ds_read_b128 v[116:119], v2 offset:11264
s_waitcnt lgkmcnt(4)
v_mfma_f32_32x32x16_bf16 v[24:39], v[128:131], a[120:123], v[24:39]
ds_read_b128 v[120:123], v2 offset:12288
s_add_u32 s39, s3, 8414208
s_add_u32 m0, s59, 24576
s_nop 0
buffer_load_dwordx4 v1, s[4:7], s39 offen offset:0 lds
v_mfma_f32_32x32x16_bf16 v[24:39], v[132:135], a[124:127], v[24:39]
ds_read_b128 v[124:127], v2 offset:13312
s_waitcnt lgkmcnt(4)
v_mfma_f32_32x32x16_bf16 v[24:39], v[104:107], a[128:131], v[24:39]
ds_read_b128 v[128:131], v2 offset:14336
v_mfma_f32_32x32x16_bf16 v[24:39], v[108:111], a[132:135], v[24:39]
ds_read_b128 v[132:135], v2 offset:15360
s_barrier
s_waitcnt lgkmcnt(4)
v_mfma_f32_32x32x16_bf16 v[24:39], v[112:115], a[136:139], v[24:39]
ds_read_b128 v[104:107], v2 offset:57344
s_add_u32 s39, s3, 8415232
s_add_u32 m0, s59, 40960
s_nop 0
buffer_load_dwordx4 v1, s[4:7], s39 offen offset:0 lds
v_mfma_f32_32x32x16_bf16 v[24:39], v[116:119], a[140:143], v[24:39]
ds_read_b128 v[108:111], v2 offset:58368
s_waitcnt lgkmcnt(4)
v_mfma_f32_32x32x16_bf16 v[24:39], v[120:123], a[144:147], v[24:39]
ds_read_b128 v[112:115], v2 offset:59392
buffer_load_dwordx4 v1, s[4:7], s39 offen offset:1024 lds
v_mfma_f32_32x32x16_bf16 v[24:39], v[124:127], a[148:151], v[24:39]
ds_read_b128 v[116:119], v2 offset:60416
s_waitcnt lgkmcnt(4)
v_mfma_f32_32x32x16_bf16 v[24:39], v[128:131], a[152:155], v[24:39]
ds_read_b128 v[120:123], v2 offset:61440
buffer_load_dwordx4 v1, s[4:7], s39 offen offset:2048 lds
v_mfma_f32_32x32x16_bf16 v[24:39], v[132:135], a[156:159], v[24:39]
ds_read_b128 v[124:127], v2 offset:62464
v_mfma_f32_32x32x16_bf16 v[24:39], a[180:183], v[144:147], v[24:39]
s_waitcnt lgkmcnt(4)
v_mfma_f32_32x32x16_bf16 v[40:55], v[104:107], a[0:3], 0
ds_read_b128 v[128:131], v2 offset:63488
v_mfma_f32_32x32x16_bf16 v[40:55], v[108:111], a[4:7], v[40:55]
ds_read_b128 v[132:135], v2 offset:64512
buffer_load_dwordx4 v1, s[4:7], s39 offen offset:3072 lds
s_waitcnt lgkmcnt(4)
v_mfma_f32_32x32x16_bf16 v[40:55], v[112:115], a[8:11], v[40:55]
ds_read_b128 v[104:107], v3 offset:0
v_mfma_f32_32x32x16_bf16 v[40:55], v[116:119], a[12:15], v[40:55]
ds_read_b128 v[108:111], v3 offset:1024
s_add_u32 s39, s3, 8419328
s_add_u32 m0, s59, 45056
s_nop 0
buffer_load_dwordx4 v1, s[4:7], s39 offen offset:0 lds
v_mul_f32 v24, v24, v148
v_mul_f32 v25, v25, v148
v_mul_f32 v26, v26, v148
s_waitcnt lgkmcnt(4)
v_mfma_f32_32x32x16_bf16 v[40:55], v[120:123], a[16:19], v[40:55]
ds_read_b128 v[112:115], v3 offset:2048
v_mul_f32 v27, v27, v148
v_exp_f32 v24, v24
v_mfma_f32_32x32x16_bf16 v[40:55], v[124:127], a[20:23], v[40:55]
ds_read_b128 v[116:119], v3 offset:3072
v_exp_f32 v25, v25
v_exp_f32 v26, v26
v_exp_f32 v27, v27
s_waitcnt lgkmcnt(4)
v_mfma_f32_32x32x16_bf16 v[40:55], v[128:131], a[24:27], v[40:55]
ds_read_b128 v[120:123], v3 offset:4096
s_add_u32 s39, s3, 8420352
s_add_u32 m0, s59, 61440
s_nop 0
buffer_load_dwordx4 v1, s[4:7], s39 offen offset:0 lds
v_fma_f32 v24, v24, v150, v150
v_mfma_f32_32x32x16_bf16 v[40:55], v[132:135], a[28:31], v[40:55]
ds_read_b128 v[124:127], v3 offset:5120
v_fma_f32 v25, v25, v150, v150
v_fma_f32 v26, v26, v150, v150
v_fma_f32 v27, v27, v150, v150
v_rcp_f32 v24, v24
s_waitcnt lgkmcnt(4)
v_mfma_f32_32x32x16_bf16 v[40:55], v[104:107], a[32:35], v[40:55]
ds_read_b128 v[128:131], v3 offset:6144
s_cmp_eq_u32 s16, 0
s_cbranch_scc0 L_if37
s_lshl_b32 s101, s17, 4
s_add_u32 s101, s101, s18
s_lshl_b32 s101, s101, 8
s_add_u32 s101, s101, s30
v_mov_b32 v23, 0
buffer_atomic_add v23, v22, s[4:7], s101 offen offset:12 sc0 sc1
L_if37:
buffer_load_dwordx4 v1, s[4:7], s39 offen offset:1024 lds
v_mfma_f32_32x32x16_bf16 v[40:55], v[108:111], a[36:39], v[40:55]
ds_read_b128 v[132:135], v3 offset:7168
v_rcp_f32 v25, v25
v_rcp_f32 v26, v26
v_rcp_f32 v27, v27
s_waitcnt lgkmcnt(4)
v_mfma_f32_32x32x16_bf16 v[40:55], v[112:115], a[40:43], v[40:55]
ds_read_b128 v[104:107], v3 offset:8192
v_mul_f32 v24, v24, v32
v_mul_f32 v25, v25, v33
v_mul_f32 v26, v26, v34
v_mul_f32 v27, v27, v35
v_mfma_f32_32x32x16_bf16 v[40:55], v[116:119], a[44:47], v[40:55]
ds_read_b128 v[108:111], v3 offset:9216
buffer_load_dwordx4 v1, s[4:7], s39 offen offset:2048 lds
v_cvt_pk_bf16_f32 v160, v24, v25
v_cvt_pk_bf16_f32 v161, v26, v27
v_mul_f32 v28, v28, v148
s_waitcnt lgkmcnt(4)
v_mfma_f32_32x32x16_bf16 v[40:55], v[120:123], a[48:51], v[40:55]
ds_read_b128 v[112:115], v3 offset:10240
v_mul_f32 v29, v29, v148
v_mul_f32 v30, v30, v148
v_mul_f32 v31, v31, v148
v_exp_f32 v28, v28
v_mfma_f32_32x32x16_bf16 v[40:55], v[124:127], a[52:55], v[40:55]
ds_read_b128 v[116:119], v3 offset:11264
buffer_load_dwordx4 v1, s[4:7], s39 offen offset:3072 lds
v_exp_f32 v29, v29
s_waitcnt lgkmcnt(4)
v_mfma_f32_32x32x16_bf16 v[40:55], v[128:131], a[56:59], v[40:55]
ds_read_b128 v[120:123], v3 offset:12288
v_exp_f32 v30, v30
v_exp_f32 v31, v31
v_fma_f32 v28, v28, v150, v150
v_fma_f32 v29, v29, v150, v150
v_mfma_f32_32x32x16_bf16 v[40:55], v[132:135], a[60:63], v[40:55]
ds_read_b128 v[124:127], v3 offset:13312
v_fma_f32 v30, v30, v150, v150
v_fma_f32 v31, v31, v150, v150
v_rcp_f32 v28, v28
s_waitcnt lgkmcnt(4)
v_mfma_f32_32x32x16_bf16 v[40:55], v[104:107], a[64:67], v[40:55]
ds_read_b128 v[128:131], v3 offset:14336
s_add_u32 s39, s3, 8424448
s_add_u32 m0, s59, 65536
s_nop 0
buffer_load_dwordx4 v1, s[4:7], s39 offen offset:0 lds
v_rcp_f32 v29, v29
v_mfma_f32_32x32x16_bf16 v[40:55], v[108:111], a[68:71], v[40:55]
ds_read_b128 v[132:135], v3 offset:15360
v_rcp_f32 v30, v30
v_rcp_f32 v31, v31
s_waitcnt lgkmcnt(4)
v_mfma_f32_32x32x16_bf16 v[40:55], v[112:115], a[72:75], v[40:55]
ds_read_b128 v[104:107], v3 offset:16384
v_mul_f32 v28, v28, v36
v_mul_f32 v29, v29, v37
v_mul_f32 v30, v30, v38
v_mul_f32 v31, v31, v39
v_mfma_f32_32x32x16_bf16 v[40:55], v[116:119], a[76:79], v[40:55]
ds_read_b128 v[108:111], v3 offset:17408
v_cvt_pk_bf16_f32 v162, v28, v29
v_cvt_pk_bf16_f32 v163, v30, v31
buffer_store_dwordx4 v[160:163], v15, s[4:7], s15 offen offset:512 sc1
s_waitcnt lgkmcnt(4)
v_mfma_f32_32x32x16_bf16 v[40:55], v[120:123], a[80:83], v[40:55]
ds_read_b128 v[112:115], v3 offset:18432
v_mfma_f32_32x32x16_bf16 v[40:55], v[124:127], a[84:87], v[40:55]
ds_read_b128 v[116:119], v3 offset:19456
s_waitcnt lgkmcnt(4)
v_mfma_f32_32x32x16_bf16 v[40:55], v[128:131], a[88:91], v[40:55]
ds_read_b128 v[120:123], v3 offset:20480
v_mfma_f32_32x32x16_bf16 v[40:55], v[132:135], a[92:95], v[40:55]
ds_read_b128 v[124:127], v3 offset:21504
s_waitcnt lgkmcnt(4)
v_mfma_f32_32x32x16_bf16 v[40:55], v[104:107], a[96:99], v[40:55]
ds_read_b128 v[128:131], v3 offset:22528
v_mfma_f32_32x32x16_bf16 v[40:55], v[108:111], a[100:103], v[40:55]
ds_read_b128 v[132:135], v3 offset:23552
s_waitcnt lgkmcnt(4)
v_mfma_f32_32x32x16_bf16 v[40:55], v[112:115], a[104:107], v[40:55]
ds_read_b128 v[104:107], v3 offset:24576
v_mfma_f32_32x32x16_bf16 v[40:55], v[116:119], a[108:111], v[40:55]
ds_read_b128 v[108:111], v3 offset:25600
s_waitcnt lgkmcnt(4)
v_mfma_f32_32x32x16_bf16 v[40:55], v[120:123], a[112:115], v[40:55]
ds_read_b128 v[112:115], v3 offset:26624
v_mfma_f32_32x32x16_bf16 v[40:55], v[124:127], a[116:119], v[40:55]
ds_read_b128 v[116:119], v3 offset:27648
s_waitcnt lgkmcnt(4)
v_mfma_f32_32x32x16_bf16 v[40:55], v[128:131], a[120:123], v[40:55]
ds_read_b128 v[120:123], v3 offset:28672
v_mfma_f32_32x32x16_bf16 v[40:55], v[132:135], a[124:127], v[40:55]
ds_read_b128 v[124:127], v3 offset:29696
s_waitcnt lgkmcnt(4)
v_mfma_f32_32x32x16_bf16 v[40:55], v[104:107], a[128:131], v[40:55]
ds_read_b128 v[128:131], v3 offset:30720
s_cmp_eq_u32 s16, 0
s_cbranch_scc0 L_if36
s_waitcnt vmcnt(5)
v_readfirstlane_b32 s23, v23
s_mov_b32 s33, 0
s_cmp_ge_u32 s23, 16
s_cbranch_scc1 L_polld5
L_poll5:
v_mov_b32 v23, 0
buffer_atomic_add v23, v22, s[4:7], s101 offen offset:12 sc0 sc1
s_waitcnt vmcnt(0)
v_readfirstlane_b32 s23, v23
s_add_u32 s33, s33, 1
s_cmp_ge_u32 s23, 16
s_cbranch_scc1 L_polld5
s_cmp_lt_u32 s33, 400000
s_cbranch_scc1 L_poll5
L_polld5:
L_if36:
s_barrier
v_mfma_f32_32x32x16_bf16 v[40:55], v[108:111], a[132:135], v[40:55]
ds_read_b128 v[132:135], v3 offset:31744
s_waitcnt lgkmcnt(4)
v_mfma_f32_32x32x16_bf16 v[40:55], v[112:115], a[136:139], v[40:55]
buffer_load_dwordx4 a[0:3], v1, s[4:7], s34 offen offset:0 sc1
v_mfma_f32_32x32x16_bf16 v[40:55], v[116:119], a[140:143], v[40:55]
s_waitcnt lgkmcnt(2)
v_mfma_f32_32x32x16_bf16 v[40:55], v[120:123], a[144:147], v[40:55]
buffer_load_dwordx4 a[4:7], v1, s[4:7], s35 offen offset:0 sc1
v_mfma_f32_32x32x16_bf16 v[40:55], v[124:127], a[148:151], v[40:55]
s_waitcnt lgkmcnt(0)
v_mfma_f32_32x32x16_bf16 v[40:55], v[128:131], a[152:155], v[40:55]
buffer_load_dwordx4 a[8:11], v1, s[4:7], s36 offen offset:0 sc1
v_mfma_f32_32x32x16_bf16 v[40:55], v[132:135], a[156:159], v[40:55]
v_mfma_f32_32x32x16_bf16 v[40:55], a[184:187], v[144:147], v[40:55]
s_nop 11
v_pk_mul_f32 v[40:41], v[40:41], v[148:149] op_sel_hi:[1,0]
v_pk_mul_f32 v[42:43], v[42:43], v[148:149] op_sel_hi:[1,0]
buffer_load_dwordx4 a[12:15], v1, s[4:7], s37 offen offset:0 sc1
v_exp_f32 v40, v40
v_exp_f32 v41, v41
v_exp_f32 v42, v42
buffer_load_dwordx4 a[16:19], v1, s[4:7], s34 offen offset:1024 sc1
v_exp_f32 v43, v43
v_pk_fma_f32 v[40:41], v[40:41], v[150:151], v[150:151] op_sel_hi:[1,0,0]
v_pk_fma_f32 v[42:43], v[42:43], v[150:151], v[150:151] op_sel_hi:[1,0,0]
v_rcp_f32 v40, v40
buffer_load_dwordx4 a[20:23], v1, s[4:7], s35 offen offset:1024 sc1
v_rcp_f32 v41, v41
v_rcp_f32 v42, v42
v_rcp_f32 v43, v43
buffer_load_dwordx4 a[24:27], v1, s[4:7], s36 offen offset:1024 sc1
v_pk_mul_f32 v[40:41], v[40:41], v[48:49]
v_pk_mul_f32 v[42:43], v[42:43], v[50:51]
v_cvt_pk_bf16_f32 v156, v40, v41
buffer_load_dwordx4 a[28:31], v1, s[4:7], s37 offen offset:1024 sc1
v_cvt_pk_bf16_f32 v157, v42, v43
v_pk_mul_f32 v[44:45], v[44:45], v[148:149] op_sel_hi:[1,0]
v_pk_mul_f32 v[46:47], v[46:47], v[148:149] op_sel_hi:[1,0]
v_exp_f32 v44, v44
buffer_load_dwordx4 a[32:35], v1, s[4:7], s34 offen offset:2048 sc1
v_exp_f32 v45, v45
v_exp_f32 v46, v46
v_exp_f32 v47, v47
buffer_load_dwordx4 a[36:39], v1, s[4:7], s35 offen offset:2048 sc1
v_pk_fma_f32 v[44:45], v[44:45], v[150:151], v[150:151] op_sel_hi:[1,0,0]
v_pk_fma_f32 v[46:47], v[46:47], v[150:151], v[150:151] op_sel_hi:[1,0,0]
v_rcp_f32 v44, v44
buffer_load_dwordx4 a[40:43], v1, s[4:7], s36 offen offset:2048 sc1
v_rcp_f32 v45, v45
v_rcp_f32 v46, v46
v_rcp_f32 v47, v47
v_pk_mul_f32 v[44:45], v[44:45], v[52:53]
buffer_load_dwordx4 a[44:47], v1, s[4:7], s37 offen offset:2048 sc1
v_pk_mul_f32 v[46:47], v[46:47], v[54:55]
v_cvt_pk_bf16_f32 v158, v44, v45
v_cvt_pk_bf16_f32 v159, v46, v47
buffer_store_dwordx4 v[156:159], v15, s[4:7], s15 offen offset:1024 sc1
s_cmp_eq_u32 s16, 3
s_cselect_b32 s23, 1073741824, 0
v_add_u32 v151, s23, v1
s_mov_b32 s23, 27648
s_cmov_b32 s23, 26624
s_lshl_b32 s97, s16, 11
s_sub_u32 s97, s23, s97
s_cmp_eq_u32 s16, 2
s_cselect_b32 s23, 1073741824, 0
v_add_u32 v148, s23, v1
s_mul_i32 s23, s16, 5120
v_add_u32 v149, s23, v1
v_add_u32 v150, 61440, v149
s_add_u32 s23, s16, 0
s_and_b32 s23, s23, 3
s_mul_i32 s25, s23, 15360
s_add_u32 s25, s25, 102400
v_add_u32 v144, s25, v1
s_add_u32 s23, s16, 1
s_and_b32 s23, s23, 3
s_mul_i32 s25, s23, 15360
s_add_u32 s25, s25, 102400
v_add_u32 v145, s25, v1
s_add_u32 s23, s16, 2
s_and_b32 s23, s23, 3
s_mul_i32 s25, s23, 15360
s_add_u32 s25, s25, 102400
v_add_u32 v146, s25, v1
s_add_u32 s23, s16, 3
s_and_b32 s23, s23, 3
s_mul_i32 s25, s23, 15360
s_add_u32 s25, s25, 102400
v_add_u32 v147, s25, v1
v_lshlrev_b32 v24, 16, v4
v_and_b32 v25, 0xffff0000, v4
v_lshlrev_b32 v26, 16, v5
v_and_b32 v27, 0xffff0000, v5
v_lshlrev_b32 v28, 16, v6
v_and_b32 v29, 0xffff0000, v6
v_lshlrev_b32 v30, 16, v7
v_and_b32 v31, 0xffff0000, v7
v_lshlrev_b32 v32, 16, v8
v_and_b32 v33, 0xffff0000, v8
v_lshlrev_b32 v34, 16, v9
v_and_b32 v35, 0xffff0000, v9
v_lshlrev_b32 v36, 16, v10
v_and_b32 v37, 0xffff0000, v10
v_lshlrev_b32 v38, 16, v11
v_and_b32 v39, 0xffff0000, v11
v_lshlrev_b32 v40, 16, v12
v_and_b32 v41, 0xffff0000, v12
v_lshlrev_b32 v42, 16, v13
v_and_b32 v43, 0xffff0000, v13
s_waitcnt vmcnt(12)
v_mfma_f32_16x16x32_bf16 v[24:27], v[164:167], a[0:3], v[24:27]
v_mfma_f32_16x16x32_bf16 v[28:31], v[168:171], a[0:3], v[28:31]
v_mfma_f32_16x16x32_bf16 v[32:35], v[172:175], a[0:3], v[32:35]
v_mfma_f32_16x16x32_bf16 v[36:39], v[176:179], a[0:3], v[36:39]
v_mfma_f32_16x16x32_bf16 v[40:43], v[180:183], a[0:3], v[40:43]
buffer_load_dwordx4 a[48:51], v1, s[4:7], s34 offen offset:3072 sc1
s_waitcnt vmcnt(12)
v_mfma_f32_16x16x32_bf16 v[44:47], v[164:167], a[4:7], 0
v_mfma_f32_16x16x32_bf16 v[48:51], v[168:171], a[4:7], 0
v_mfma_f32_16x16x32_bf16 v[52:55], v[172:175], a[4:7], 0
v_mfma_f32_16x16x32_bf16 v[56:59], v[176:179], a[4:7], 0
v_mfma_f32_16x16x32_bf16 v[60:63], v[180:183], a[4:7], 0
buffer_load_dwordx4 a[52:55], v1, s[4:7], s35 offen offset:3072 sc1
s_waitcnt vmcnt(12)
v_mfma_f32_16x16x32_bf16 v[64:67], v[164:167], a[8:11], 0
v_mfma_f32_16x16x32_bf16 v[68:71], v[168:171], a[8:11], 0
v_mfma_f32_16x16x32_bf16 v[72:75], v[172:175], a[8:11], 0
v_mfma_f32_16x16x32_bf16 v[76:79], v[176:179], a[8:11], 0
buffer_load_dwordx4 a[56:59], v1, s[4:7], s36 offen offset:3072 sc1
v_mfma_f32_16x16x32_bf16 v[80:83], v[180:183], a[8:11], 0
s_waitcnt vmcnt(12)
v_mfma_f32_16x16x32_bf16 v[84:87], v[164:167], a[12:15], 0
v_mfma_f32_16x16x32_bf16 v[88:91], v[168:171], a[12:15], 0
v_mfma_f32_16x16x32_bf16 v[92:95], v[172:175], a[12:15], 0
v_mfma_f32_16x16x32_bf16 v[96:99], v[176:179], a[12:15], 0
buffer_load_dwordx4 a[60:63], v1, s[4:7], s37 offen offset:3072 sc1
v_mfma_f32_16x16x32_bf16 v[100:103], v[180:183], a[12:15], 0
s_waitcnt vmcnt(12)
v_mfma_f32_16x16x32_bf16 v[24:27], v[184:187], a[16:19], v[24:27]
v_mfma_f32_16x16x32_bf16 v[28:31], v[188:191], a[16:19], v[28:31]
v_mfma_f32_16x16x32_bf16 v[32:35], v[192:195], a[16:19], v[32:35]
s_add_u32 s34, s34, 4096
buffer_load_dwordx4 a[64:67], v1, s[4:7], s34 offen offset:0 sc1
v_mfma_f32_16x16x32_bf16 v[36:39], v[196:199], a[16:19], v[36:39]
v_mfma_f32_16x16x32_bf16 v[40:43], v[200:203], a[16:19], v[40:43]
s_waitcnt vmcnt(12)
v_mfma_f32_16x16x32_bf16 v[44:47], v[184:187], a[20:23], v[44:47]
v_mfma_f32_16x16x32_bf16 v[48:51], v[188:191], a[20:23], v[48:51]
v_mfma_f32_16x16x32_bf16 v[52:55], v[192:195], a[20:23], v[52:55]
s_add_u32 s35, s35, 4096
buffer_load_dwordx4 a[68:71], v1, s[4:7], s35 offen offset:0 sc1
v_mfma_f32_16x16x32_bf16 v[56:59], v[196:199], a[20:23], v[56:59]
v_mfma_f32_16x16x32_bf16 v[60:63], v[200:203], a[20:23], v[60:63]
s_waitcnt vmcnt(12)
v_mfma_f32_16x16x32_bf16 v[64:67], v[184:187], a[24:27], v[64:67]
v_mfma_f32_16x16x32_bf16 v[68:71], v[188:191], a[24:27], v[68:71]
s_add_u32 s36, s36, 4096
buffer_load_dwordx4 a[72:75], v1, s[4:7], s36 offen offset:0 sc1
v_mfma_f32_16x16x32_bf16 v[72:75], v[192:195], a[24:27], v[72:75]
v_mfma_f32_16x16x32_bf16 v[76:79], v[196:199], a[24:27], v[76:79]
v_mfma_f32_16x16x32_bf16 v[80:83], v[200:203], a[24:27], v[80:83]
s_waitcnt vmcnt(12)
v_mfma_f32_16x16x32_bf16 v[84:87], v[184:187], a[28:31], v[84:87]
v_mfma_f32_16x16x32_bf16 v[88:91], v[188:191], a[28:31], v[88:91]
s_add_u32 s37, s37, 4096
buffer_load_dwordx4 a[76:79], v1, s[4:7], s37 offen offset:0 sc1
v_mfma_f32_16x16x32_bf16 v[92:95], v[192:195], a[28:31], v[92:95]
v_mfma_f32_16x16x32_bf16 v[96:99], v[196:199], a[28:31], v[96:99]
v_mfma_f32_16x16x32_bf16 v[100:103], v[200:203], a[28:31], v[100:103]
s_waitcnt vmcnt(12)
v_mfma_f32_16x16x32_bf16 v[24:27], v[204:207], a[32:35], v[24:27]
buffer_load_dwordx4 a[80:83], v1, s[4:7], s34 offen offset:1024 sc1
v_mfma_f32_16x16x32_bf16 v[28:31], v[208:211], a[32:35], v[28:31]
v_mfma_f32_16x16x32_bf16 v[32:35], v[212:215], a[32:35], v[32:35]
v_mfma_f32_16x16x32_bf16 v[36:39], v[216:219], a[32:35], v[36:39]
v_mfma_f32_16x16x32_bf16 v[40:43], v[220:223], a[32:35], v[40:43]
s_waitcnt vmcnt(12)
v_mfma_f32_16x16x32_bf16 v[44:47], v[204:207], a[36:39], v[44:47]
buffer_load_dwordx4 a[84:87], v1, s[4:7], s35 offen offset:1024 sc1
v_mfma_f32_16x16x32_bf16 v[48:51], v[208:211], a[36:39], v[48:51]
v_mfma_f32_16x16x32_bf16 v[52:55], v[212:215], a[36:39], v[52:55]
v_mfma_f32_16x16x32_bf16 v[56:59], v[216:219], a[36:39], v[56:59]
v_mfma_f32_16x16x32_bf16 v[60:63], v[220:223], a[36:39], v[60:63]
buffer_load_dwordx4 a[88:91], v1, s[4:7], s36 offen offset:1024 sc1
s_waitcnt vmcnt(13)
v_mfma_f32_16x16x32_bf16 v[64:67], v[204:207], a[40:43], v[64:67]
v_lshlrev_b32 v23, 8, v0
s_lshl_b32 s22, s17, 12
s_add_u32 s22, s22, s30
v_cndmask_b32 v23, v22, v23, s[40:41]
s_waitcnt vmcnt(11)
s_barrier
s_cmp_eq_u32 s16, 0
s_cbranch_scc0 L_if38
buffer_atomic_add v21, v23, s[4:7], s22 offen offset:20 sc1
L_if38:
v_mfma_f32_16x16x32_bf16 v[68:71], v[208:211], a[40:43], v[68:71]
v_mfma_f32_16x16x32_bf16 v[72:75], v[212:215], a[40:43], v[72:75]
v_mfma_f32_16x16x32_bf16 v[76:79], v[216:219], a[40:43], v[76:79]
v_mfma_f32_16x16x32_bf16 v[80:83], v[220:223], a[40:43], v[80:83]
buffer_load_dwordx4 a[92:95], v1, s[4:7], s37 offen offset:1024 sc1
v_mfma_f32_16x16x32_bf16 v[84:87], v[204:207], a[44:47], v[84:87]
v_mfma_f32_16x16x32_bf16 v[88:91], v[208:211], a[44:47], v[88:91]
v_mfma_f32_16x16x32_bf16 v[92:95], v[212:215], a[44:47], v[92:95]
v_mfma_f32_16x16x32_bf16 v[96:99], v[216:219], a[44:47], v[96:99]
v_mfma_f32_16x16x32_bf16 v[100:103], v[220:223], a[44:47], v[100:103]
buffer_load_dwordx4 a[96:99], v1, s[4:7], s34 offen offset:2048 sc1
s_waitcnt vmcnt(12)
v_mfma_f32_16x16x32_bf16 v[24:27], v[224:227], a[48:51], v[24:27]
v_mfma_f32_16x16x32_bf16 v[28:31], v[228:231], a[48:51], v[28:31]
v_mfma_f32_16x16x32_bf16 v[32:35], v[232:235], a[48:51], v[32:35]
v_mfma_f32_16x16x32_bf16 v[36:39], v[236:239], a[48:51], v[36:39]
buffer_load_dwordx4 a[100:103], v1, s[4:7], s35 offen offset:2048 sc1
v_mfma_f32_16x16x32_bf16 v[40:43], v[240:243], a[48:51], v[40:43]
s_waitcnt vmcnt(12)
v_mfma_f32_16x16x32_bf16 v[44:47], v[224:227], a[52:55], v[44:47]
v_mfma_f32_16x16x32_bf16 v[48:51], v[228:231], a[52:55], v[48:51]
v_mfma_f32_16x16x32_bf16 v[52:55], v[232:235], a[52:55], v[52:55]
v_mfma_f32_16x16x32_bf16 v[56:59], v[236:239], a[52:55], v[56:59]
buffer_load_dwordx4 a[104:107], v1, s[4:7], s36 offen offset:2048 sc1
v_mfma_f32_16x16x32_bf16 v[60:63], v[240:243], a[52:55], v[60:63]
s_waitcnt vmcnt(12)
v_mfma_f32_16x16x32_bf16 v[64:67], v[224:227], a[56:59], v[64:67]
v_mfma_f32_16x16x32_bf16 v[68:71], v[228:231], a[56:59], v[68:71]
v_mfma_f32_16x16x32_bf16 v[72:75], v[232:235], a[56:59], v[72:75]
buffer_load_dwordx4 a[108:111], v1, s[4:7], s37 offen offset:2048 sc1
v_mfma_f32_16x16x32_bf16 v[76:79], v[236:239], a[56:59], v[76:79]
v_mfma_f32_16x16x32_bf16 v[80:83], v[240:243], a[56:59], v[80:83]
s_waitcnt vmcnt(12)
v_mfma_f32_16x16x32_bf16 v[84:87], v[224:227], a[60:63], v[84:87]
v_mfma_f32_16x16x32_bf16 v[88:91], v[228:231], a[60:63], v[88:91]
v_mfma_f32_16x16x32_bf16 v[92:95], v[232:235], a[60:63], v[92:95]
buffer_load_dwordx4 a[112:115], v151, s[4:7], s34 offen offset:3072 sc1
v_mfma_f32_16x16x32_bf16 v[96:99], v[236:239], a[60:63], v[96:99]
v_mfma_f32_16x16x32_bf16 v[100:103], v[240:243], a[60:63], v[100:103]
s_waitcnt vmcnt(12)
v_mfma_f32_16x16x32_bf16 v[24:27], v[244:247], a[64:67], v[24:27]
v_mfma_f32_16x16x32_bf16 v[28:31], v[248:251], a[64:67], v[28:31]
buffer_load_dwordx4 a[116:119], v151, s[4:7], s35 offen offset:3072 sc1
v_mfma_f32_16x16x32_bf16 v[32:35], v[252:255], a[64:67], v[32:35]
v_mfma_f32_16x16x32_bf16 v[36:39], a[188:191], a[64:67], v[36:39]
v_mfma_f32_16x16x32_bf16 v[40:43], a[192:195], a[64:67], v[40:43]
s_waitcnt vmcnt(12)
v_mfma_f32_16x16x32_bf16 v[44:47], v[244:247], a[68:71], v[44:47]
s_cmp_eq_u32 s16, 0
s_cbranch_scc0 L_if40
s_lshl_b32 s101, s17, 4
s_add_u32 s101, s101, s18
s_lshl_b32 s101, s101, 8
s_add_u32 s101, s101, s30
v_mov_b32 v23, 0
buffer_atomic_add v23, v22, s[4:7], s101 offen offset:20 sc0 sc1
L_if40:
v_mfma_f32_16x16x32_bf16 v[48:51], v[248:251], a[68:71], v[48:51]
buffer_load_dwordx4 a[120:123], v151, s[4:7], s36 offen offset:3072 sc1
v_mfma_f32_16x16x32_bf16 v[52:55], v[252:255], a[68:71], v[52:55]
v_mfma_f32_16x16x32_bf16 v[56:59], a[188:191], a[68:71], v[56:59]
v_mfma_f32_16x16x32_bf16 v[60:63], a[192:195], a[68:71], v[60:63]
s_waitcnt vmcnt(12)
v_mfma_f32_16x16x32_bf16 v[64:67], v[244:247], a[72:75], v[64:67]
buffer_load_dwordx4 a[124:127], v151, s[4:7], s37 offen offset:3072 sc1
v_mfma_f32_16x16x32_bf16 v[68:71], v[248:251], a[72:75], v[68:71]
v_mfma_f32_16x16x32_bf16 v[72:75], v[252:255], a[72:75], v[72:75]
v_mfma_f32_16x16x32_bf16 v[76:79], a[188:191], a[72:75], v[76:79]
v_mfma_f32_16x16x32_bf16 v[80:83], a[192:195], a[72:75], v[80:83]
s_waitcnt vmcnt(12)
v_mfma_f32_16x16x32_bf16 v[84:87], v[244:247], a[76:79], v[84:87]
s_add_u32 s38, s3, 8430592
buffer_load_dwordx4 a[128:131], v1, s[4:7], s38 offen offset:0
v_mfma_f32_16x16x32_bf16 v[88:91], v[248:251], a[76:79], v[88:91]
v_mfma_f32_16x16x32_bf16 v[92:95], v[252:255], a[76:79], v[92:95]
v_mfma_f32_16x16x32_bf16 v[96:99], a[188:191], a[76:79], v[96:99]
v_mfma_f32_16x16x32_bf16 v[100:103], a[192:195], a[76:79], v[100:103]
buffer_load_dwordx4 a[132:135], v1, s[4:7], s38 offen offset:1024
s_waitcnt vmcnt(13)
v_mfma_f32_16x16x32_bf16 v[24:27], a[196:199], a[80:83], v[24:27]
v_mfma_f32_16x16x32_bf16 v[28:31], a[200:203], a[80:83], v[28:31]
v_mfma_f32_16x16x32_bf16 v[32:35], a[204:207], a[80:83], v[32:35]
v_mfma_f32_16x16x32_bf16 v[36:39], a[208:211], a[80:83], v[36:39]
v_mfma_f32_16x16x32_bf16 v[40:43], a[212:215], a[80:83], v[40:43]
buffer_load_dwordx4 a[136:139], v1, s[4:7], s38 offen offset:2048
s_waitcnt vmcnt(13)
v_mfma_f32_16x16x32_bf16 v[44:47], a[196:199], a[84:87], v[44:47]
v_mfma_f32_16x16x32_bf16 v[48:51], a[200:203], a[84:87], v[48:51]
v_mfma_f32_16x16x32_bf16 v[52:55], a[204:207], a[84:87], v[52:55]
v_mfma_f32_16x16x32_bf16 v[56:59], a[208:211], a[84:87], v[56:59]
v_mfma_f32_16x16x32_bf16 v[60:63], a[212:215], a[84:87], v[60:63]
buffer_load_dwordx4 a[140:143], v1, s[4:7], s38 offen offset:3072
s_waitcnt vmcnt(13)
v_mfma_f32_16x16x32_bf16 v[64:67], a[196:199], a[88:91], v[64:67]
v_mfma_f32_16x16x32_bf16 v[68:71], a[200:203], a[88:91], v[68:71]
v_mfma_f32_16x16x32_bf16 v[72:75], a[204:207], a[88:91], v[72:75]
v_mfma_f32_16x16x32_bf16 v[76:79], a[208:211], a[88:91], v[76:79]
s_add_u32 s38, s3, 8434688
buffer_load_dwordx4 a[144:147], v1, s[4:7], s38 offen offset:0
v_mfma_f32_16x16x32_bf16 v[80:83], a[212:215], a[88:91], v[80:83]
s_waitcnt vmcnt(13)
v_mfma_f32_16x16x32_bf16 v[84:87], a[196:199], a[92:95], v[84:87]
v_mfma_f32_16x16x32_bf16 v[88:91], a[200:203], a[92:95], v[88:91]
v_mfma_f32_16x16x32_bf16 v[92:95], a[204:207], a[92:95], v[92:95]
v_mfma_f32_16x16x32_bf16 v[96:99], a[208:211], a[92:95], v[96:99]
v_mfma_f32_16x16x32_bf16 v[100:103], a[212:215], a[92:95], v[100:103]
s_waitcnt vmcnt(12)
v_mfma_f32_16x16x32_bf16 v[24:27], a[216:219], a[96:99], v[24:27]
v_mfma_f32_16x16x32_bf16 v[28:31], a[220:223], a[96:99], v[28:31]
v_mfma_f32_16x16x32_bf16 v[32:35], a[224:227], a[96:99], v[32:35]
v_mfma_f32_16x16x32_bf16 v[36:39], a[228:231], a[96:99], v[36:39]
v_mfma_f32_16x16x32_bf16 v[40:43], a[232:235], a[96:99], v[40:43]
s_waitcnt vmcnt(11)
v_mfma_f32_16x16x32_bf16 v[44:47], a[216:219], a[100:103], v[44:47]
s_cmp_eq_u32 s16, 0
s_cbranch_scc0 L_if39
s_waitcnt vmcnt(7)
v_readfirstlane_b32 s23, v23
s_mov_b32 s33, 0
s_cmp_ge_u32 s23, 16
s_cbranch_scc1 L_polld6
L_poll6:
v_mov_b32 v23, 0
buffer_atomic_add v23, v22, s[4:7], s101 offen offset:20 sc0 sc1
s_waitcnt vmcnt(0)
v_readfirstlane_b32 s23, v23
s_add_u32 s33, s33, 1
s_cmp_ge_u32 s23, 16
s_cbranch_scc1 L_polld6
s_cmp_lt_u32 s33, 400000
s_cbranch_scc1 L_poll6
L_polld6:
L_if39:
s_barrier
s_add_u32 s34, s34, s97
s_add_u32 s26, s34, 5120
buffer_load_dwordx4 a[0:3], v148, s[4:7], s26 offen sc1
s_add_u32 s35, s35, s97
s_add_u32 s26, s35, 5120
buffer_load_dwordx4 a[4:7], v148, s[4:7], s26 offen sc1
s_add_u32 s36, s36, s97
s_add_u32 s26, s36, 5120
buffer_load_dwordx4 a[8:11], v148, s[4:7], s26 offen sc1
s_add_u32 s37, s37, s97
s_add_u32 s26, s37, 5120
buffer_load_dwordx4 a[12:15], v148, s[4:7], s26 offen sc1
v_mfma_f32_16x16x32_bf16 v[48:51], a[220:223], a[100:103], v[48:51]
v_mfma_f32_16x16x32_bf16 v[52:55], a[224:227], a[100:103], v[52:55]
v_mfma_f32_16x16x32_bf16 v[56:59], a[228:231], a[100:103], v[56:59]
v_mfma_f32_16x16x32_bf16 v[60:63], a[232:235], a[100:103], v[60:63]
buffer_load_dwordx4 a[16:19], v1, s[4:7], s34 offen offset:0 sc1
s_waitcnt vmcnt(15)
v_mfma_f32_16x16x32_bf16 v[64:67], a[216:219], a[104:107], v[64:67]
v_mfma_f32_16x16x32_bf16 v[68:71], a[220:223], a[104:107], v[68:71]
v_mfma_f32_16x16x32_bf16 v[72:75], a[224:227], a[104:107], v[72:75]
v_mfma_f32_16x16x32_bf16 v[76:79], a[228:231], a[104:107], v[76:79]
v_mfma_f32_16x16x32_bf16 v[80:83], a[232:235], a[104:107], v[80:83]
buffer_load_dwordx4 a[20:23], v1, s[4:7], s35 offen offset:0 sc1
s_waitcnt vmcnt(15)
v_mfma_f32_16x16x32_bf16 v[84:87], a[216:219], a[108:111], v[84:87]
v_mfma_f32_16x16x32_bf16 v[88:91], a[220:223], a[108:111], v[88:91]
v_mfma_f32_16x16x32_bf16 v[92:95], a[224:227], a[108:111], v[92:95]
v_mfma_f32_16x16x32_bf16 v[96:99], a[228:231], a[108:111], v[96:99]
buffer_load_dwordx4 a[24:27], v1, s[4:7], s36 offen offset:0 sc1
v_mfma_f32_16x16x32_bf16 v[100:103], a[232:235], a[108:111], v[100:103]
s_waitcnt vmcnt(15)
v_mfma_f32_16x16x32_bf16 v[24:27], a[236:239], a[112:115], v[24:27]
v_mfma_f32_16x16x32_bf16 v[28:31], a[240:243], a[112:115], v[28:31]
v_mfma_f32_16x16x32_bf16 v[32:35], a[244:247], a[112:115], v[32:35]
v_mfma_f32_16x16x32_bf16 v[36:39], a[248:251], a[112:115], v[36:39]
buffer_load_dwordx4 a[28:31], v1, s[4:7], s37 offen offset:0 sc1
v_mfma_f32_16x16x32_bf16 v[40:43], a[252:255], a[112:115], v[40:43]
s_waitcnt vmcnt(15)
v_mfma_f32_16x16x32_bf16 v[44:47], a[236:239], a[116:119], v[44:47]
v_mfma_f32_16x16x32_bf16 v[48:51], a[240:243], a[116:119], v[48:51]
v_mfma_f32_16x16x32_bf16 v[52:55], a[244:247], a[116:119], v[52:55]
buffer_load_dwordx4 a[32:35], v1, s[4:7], s34 offen offset:1024 sc1
v_mfma_f32_16x16x32_bf16 v[56:59], a[248:251], a[116:119], v[56:59]
v_mfma_f32_16x16x32_bf16 v[60:63], a[252:255], a[116:119], v[60:63]
s_waitcnt vmcnt(15)
v_mfma_f32_16x16x32_bf16 v[64:67], a[236:239], a[120:123], v[64:67]
v_mfma_f32_16x16x32_bf16 v[68:71], a[240:243], a[120:123], v[68:71]
v_mfma_f32_16x16x32_bf16 v[72:75], a[244:247], a[120:123], v[72:75]
buffer_load_dwordx4 a[36:39], v1, s[4:7], s35 offen offset:1024 sc1
v_mfma_f32_16x16x32_bf16 v[76:79], a[248:251], a[120:123], v[76:79]
v_mfma_f32_16x16x32_bf16 v[80:83], a[252:255], a[120:123], v[80:83]
s_waitcnt vmcnt(15)
v_mfma_f32_16x16x32_bf16 v[84:87], a[236:239], a[124:127], v[84:87]
v_mfma_f32_16x16x32_bf16 v[88:91], a[240:243], a[124:127], v[88:91]
buffer_load_dwordx4 a[40:43], v1, s[4:7], s36 offen offset:1024 sc1
v_mfma_f32_16x16x32_bf16 v[92:95], a[244:247], a[124:127], v[92:95]
v_mfma_f32_16x16x32_bf16 v[96:99], a[248:251], a[124:127], v[96:99]
v_mfma_f32_16x16x32_bf16 v[100:103], a[252:255], a[124:127], v[100:103]
s_waitcnt vmcnt(10)
v_mfma_f32_16x16x32_bf16 v[24:27], a[128:131], a[0:3], v[24:27]
ds_read_b128 v[104:107], v149 offset:0
v_mfma_f32_16x16x32_bf16 v[28:31], a[132:135], a[0:3], v[28:31]
buffer_load_dwordx4 a[44:47], v1, s[4:7], s37 offen offset:1024 sc1
v_mfma_f32_16x16x32_bf16 v[32:35], a[136:139], a[0:3], v[32:35]
ds_read_b128 v[108:111], v149 offset:1024
v_mfma_f32_16x16x32_bf16 v[36:39], a[140:143], a[0:3], v[36:39]
v_mfma_f32_16x16x32_bf16 v[40:43], a[144:147], a[0:3], v[40:43]
ds_read_b128 v[112:115], v149 offset:2048
s_waitcnt vmcnt(10)
v_mfma_f32_16x16x32_bf16 v[44:47], a[128:131], a[4:7], v[44:47]
buffer_load_dwordx4 a[48:51], v1, s[4:7], s34 offen offset:2048 sc1
v_mfma_f32_16x16x32_bf16 v[48:51], a[132:135], a[4:7], v[48:51]
ds_read_b128 v[116:119], v149 offset:3072
v_mfma_f32_16x16x32_bf16 v[52:55], a[136:139], a[4:7], v[52:55]
v_mfma_f32_16x16x32_bf16 v[56:59], a[140:143], a[4:7], v[56:59]
ds_read_b128 v[120:123], v149 offset:4096
v_mfma_f32_16x16x32_bf16 v[60:63], a[144:147], a[4:7], v[60:63]
s_waitcnt vmcnt(10)
v_mfma_f32_16x16x32_bf16 v[64:67], a[128:131], a[8:11], v[64:67]
ds_read_b128 v[124:127], v149 offset:20480
buffer_load_dwordx4 a[52:55], v1, s[4:7], s35 offen offset:2048 sc1
v_mfma_f32_16x16x32_bf16 v[68:71], a[132:135], a[8:11], v[68:71]
v_mfma_f32_16x16x32_bf16 v[72:75], a[136:139], a[8:11], v[72:75]
ds_read_b128 v[128:131], v149 offset:21504
v_mfma_f32_16x16x32_bf16 v[76:79], a[140:143], a[8:11], v[76:79]
v_mfma_f32_16x16x32_bf16 v[80:83], a[144:147], a[8:11], v[80:83]
ds_read_b128 v[132:135], v149 offset:22528
buffer_load_dwordx4 a[56:59], v1, s[4:7], s36 offen offset:2048 sc1
s_waitcnt vmcnt(11)
v_mfma_f32_16x16x32_bf16 v[84:87], a[128:131], a[12:15], v[84:87]
v_mfma_f32_16x16x32_bf16 v[88:91], a[132:135], a[12:15], v[88:91]
v_mfma_f32_16x16x32_bf16 v[92:95], a[136:139], a[12:15], v[92:95]
v_mfma_f32_16x16x32_bf16 v[96:99], a[140:143], a[12:15], v[96:99]
v_mfma_f32_16x16x32_bf16 v[100:103], a[144:147], a[12:15], v[100:103]
buffer_load_dwordx4 a[60:63], v1, s[4:7], s37 offen offset:2048 sc1
s_waitcnt vmcnt(11) lgkmcnt(7)
v_mfma_f32_16x16x32_bf16 v[24:27], v[104:107], a[16:19], v[24:27]
ds_read_b128 v[136:139], v149 offset:23552
s_waitcnt vmcnt(10)
v_mfma_f32_16x16x32_bf16 v[44:47], v[104:107], a[20:23], v[44:47]
s_waitcnt vmcnt(9)
v_mfma_f32_16x16x32_bf16 v[64:67], v[104:107], a[24:27], v[64:67]
s_waitcnt vmcnt(8)
v_mfma_f32_16x16x32_bf16 v[84:87], v[104:107], a[28:31], v[84:87]
s_waitcnt lgkmcnt(7)
v_mfma_f32_16x16x32_bf16 v[28:31], v[108:111], a[16:19], v[28:31]
ds_read_b128 v[140:143], v149 offset:24576
buffer_load_dwordx4 a[68:71], v1, s[4:7], s35 offen offset:3072 sc1
v_mfma_f32_16x16x32_bf16 v[48:51], v[108:111], a[20:23], v[48:51]
v_mfma_f32_16x16x32_bf16 v[68:71], v[108:111], a[24:27], v[68:71]
v_mfma_f32_16x16x32_bf16 v[88:91], v[108:111], a[28:31], v[88:91]
s_waitcnt lgkmcnt(7)
v_mfma_f32_16x16x32_bf16 v[32:35], v[112:115], a[16:19], v[32:35]
ds_read_b128 v[104:107], v149 offset:40960
s_add_u32 s35, s35, 4096
buffer_load_dwordx4 a[84:87], v1, s[4:7], s35 offen offset:0 sc1
v_mfma_f32_16x16x32_bf16 v[52:55], v[112:115], a[20:23], v[52:55]
v_mfma_f32_16x16x32_bf16 v[72:75], v[112:115], a[24:27], v[72:75]
v_mfma_f32_16x16x32_bf16 v[92:95], v[112:115], a[28:31], v[92:95]
s_waitcnt lgkmcnt(7)
v_mfma_f32_16x16x32_bf16 v[36:39], v[116:119], a[16:19], v[36:39]
ds_read_b128 v[108:111], v149 offset:41984
v_mfma_f32_16x16x32_bf16 v[56:59], v[116:119], a[20:23], v[56:59]
buffer_load_dwordx4 a[72:75], v1, s[4:7], s36 offen offset:3072 sc1
v_mfma_f32_16x16x32_bf16 v[76:79], v[116:119], a[24:27], v[76:79]
v_mfma_f32_16x16x32_bf16 v[96:99], v[116:119], a[28:31], v[96:99]
s_waitcnt lgkmcnt(7)
v_mfma_f32_16x16x32_bf16 v[40:43], v[120:123], a[16:19], v[40:43]
ds_read_b128 v[112:115], v149 offset:43008
v_mfma_f32_16x16x32_bf16 v[60:63], v[120:123], a[20:23], v[60:63]
s_add_u32 s36, s36, 4096
buffer_load_dwordx4 a[88:91], v1, s[4:7], s36 offen offset:0 sc1
v_mfma_f32_16x16x32_bf16 v[80:83], v[120:123], a[24:27], v[80:83]
v_mfma_f32_16x16x32_bf16 v[100:103], v[120:123], a[28:31], v[100:103]
s_waitcnt vmcnt(11) lgkmcnt(7)
v_mfma_f32_16x16x32_bf16 v[24:27], v[124:127], a[32:35], v[24:27]
ds_read_b128 v[116:119], v149 offset:44032
s_waitcnt vmcnt(10)
v_mfma_f32_16x16x32_bf16 v[44:47], v[124:127], a[36:39], v[44:47]
s_waitcnt vmcnt(9)
v_mfma_f32_16x16x32_bf16 v[64:67], v[124:127], a[40:43], v[64:67]
buffer_load_dwordx4 a[76:79], v1, s[4:7], s37 offen offset:3072 sc1
s_waitcnt vmcnt(9)
v_mfma_f32_16x16x32_bf16 v[84:87], v[124:127], a[44:47], v[84:87]
s_waitcnt lgkmcnt(7)
v_mfma_f32_16x16x32_bf16 v[28:31], v[128:131], a[32:35], v[28:31]
ds_read_b128 v[120:123], v149 offset:45056
v_mfma_f32_16x16x32_bf16 v[48:51], v[128:131], a[36:39], v[48:51]
v_mfma_f32_16x16x32_bf16 v[68:71], v[128:131], a[40:43], v[68:71]
s_add_u32 s37, s37, 4096
buffer_load_dwordx4 a[92:95], v1, s[4:7], s37 offen offset:0 sc1
v_mfma_f32_16x16x32_bf16 v[88:91], v[128:131], a[44:47], v[88:91]
s_waitcnt lgkmcnt(7)
v_mfma_f32_16x16x32_bf16 v[32:35], v[132:135], a[32:35], v[32:35]
ds_read_b128 v[124:127], v150 offset:0
v_mfma_f32_16x16x32_bf16 v[52:55], v[132:135], a[36:39], v[52:55]
v_mfma_f32_16x16x32_bf16 v[72:75], v[132:135], a[40:43], v[72:75]
v_mfma_f32_16x16x32_bf16 v[92:95], v[132:135], a[44:47], v[92:95]
buffer_load_dwordx4 a[64:67], v1, s[4:7], s34 offen offset:3072 sc1
s_waitcnt lgkmcnt(7)
v_mfma_f32_16x16x32_bf16 v[36:39], v[136:139], a[32:35], v[36:39]
ds_read_b128 v[128:131], v150 offset:1024
v_mfma_f32_16x16x32_bf16 v[56:59], v[136:139], a[36:39], v[56:59]
v_mfma_f32_16x16x32_bf16 v[76:79], v[136:139], a[40:43], v[76:79]
v_mfma_f32_16x16x32_bf16 v[96:99], v[136:139], a[44:47], v[96:99]
s_add_u32 s34, s34, 4096
buffer_load_dwordx4 a[80:83], v1, s[4:7], s34 offen offset:0 sc1
s_waitcnt lgkmcnt(7)
v_mfma_f32_16x16x32_bf16 v[40:43], v[140:143], a[32:35], v[40:43]
ds_read_b128 v[132:135], v150 offset:2048
v_mfma_f32_16x16x32_bf16 v[60:63], v[140:143], a[36:39], v[60:63]
v_mfma_f32_16x16x32_bf16 v[80:83], v[140:143], a[40:43], v[80:83]
v_mfma_f32_16x16x32_bf16 v[100:103], v[140:143], a[44:47], v[100:103]
s_waitcnt vmcnt(11) lgkmcnt(7)
v_mfma_f32_16x16x32_bf16 v[24:27], v[104:107], a[48:51], v[24:27]
ds_read_b128 v[136:139], v150 offset:3072
s_waitcnt vmcnt(10)
v_mfma_f32_16x16x32_bf16 v[44:47], v[104:107], a[52:55], v[44:47]
s_waitcnt vmcnt(9)
v_mfma_f32_16x16x32_bf16 v[64:67], v[104:107], a[56:59], v[64:67]
s_waitcnt vmcnt(8)
v_mfma_f32_16x16x32_bf16 v[84:87], v[104:107], a[60:63], v[84:87]
s_waitcnt lgkmcnt(7)
v_mfma_f32_16x16x32_bf16 v[28:31], v[108:111], a[48:51], v[28:31]
ds_read_b128 v[140:143], v150 offset:4096
v_mfma_f32_16x16x32_bf16 v[48:51], v[108:111], a[52:55], v[48:51]
v_mfma_f32_16x16x32_bf16 v[68:71], v[108:111], a[56:59], v[68:71]
v_mfma_f32_16x16x32_bf16 v[88:91], v[108:111], a[60:63], v[88:91]
s_waitcnt lgkmcnt(7)
v_mfma_f32_16x16x32_bf16 v[32:35], v[112:115], a[48:51], v[32:35]
ds_read_b128 v[104:107], v150 offset:20480
v_mfma_f32_16x16x32_bf16 v[52:55], v[112:115], a[52:55], v[52:55]
v_mfma_f32_16x16x32_bf16 v[72:75], v[112:115], a[56:59], v[72:75]
v_mfma_f32_16x16x32_bf16 v[92:95], v[112:115], a[60:63], v[92:95]
s_waitcnt lgkmcnt(7)
v_mfma_f32_16x16x32_bf16 v[36:39], v[116:119], a[48:51], v[36:39]
ds_read_b128 v[108:111], v150 offset:21504
v_mfma_f32_16x16x32_bf16 v[56:59], v[116:119], a[52:55], v[56:59]
v_mfma_f32_16x16x32_bf16 v[76:79], v[116:119], a[56:59], v[76:79]
v_mfma_f32_16x16x32_bf16 v[96:99], v[116:119], a[60:63], v[96:99]
ds_read_b128 v[116:119], v150 offset:23552
s_waitcnt lgkmcnt(8)
v_mfma_f32_16x16x32_bf16 v[40:43], v[120:123], a[48:51], v[40:43]
ds_read_b128 v[112:115], v150 offset:22528
v_mfma_f32_16x16x32_bf16 v[60:63], v[120:123], a[52:55], v[60:63]
v_mfma_f32_16x16x32_bf16 v[80:83], v[120:123], a[56:59], v[80:83]
v_mfma_f32_16x16x32_bf16 v[100:103], v[120:123], a[60:63], v[100:103]
ds_read_b128 v[120:123], v150 offset:24576
s_waitcnt vmcnt(7) lgkmcnt(9)
v_mfma_f32_16x16x32_bf16 v[44:47], v[124:127], a[68:71], v[44:47]
s_waitcnt lgkmcnt(8)
v_mfma_f32_16x16x32_bf16 v[48:51], v[128:131], a[68:71], v[48:51]
s_waitcnt lgkmcnt(7)
v_mfma_f32_16x16x32_bf16 v[52:55], v[132:135], a[68:71], v[52:55]
s_waitcnt lgkmcnt(6)
v_mfma_f32_16x16x32_bf16 v[56:59], v[136:139], a[68:71], v[56:59]
s_waitcnt lgkmcnt(5)
v_mfma_f32_16x16x32_bf16 v[60:63], v[140:143], a[68:71], v[60:63]
s_waitcnt vmcnt(6) lgkmcnt(4)
v_mfma_f32_16x16x32_bf16 v[44:47], v[104:107], a[84:87], v[44:47]
s_waitcnt lgkmcnt(3)
v_mfma_f32_16x16x32_bf16 v[48:51], v[108:111], a[84:87], v[48:51]
s_waitcnt lgkmcnt(1)
v_mfma_f32_16x16x32_bf16 v[52:55], v[112:115], a[84:87], v[52:55]
v_mfma_f32_16x16x32_bf16 v[56:59], v[116:119], a[84:87], v[56:59]
s_waitcnt lgkmcnt(0)
v_mfma_f32_16x16x32_bf16 v[60:63], v[120:123], a[84:87], v[60:63]
s_waitcnt vmcnt(5)
v_mfma_f32_16x16x32_bf16 v[64:67], v[124:127], a[72:75], v[64:67]
s_nop 2
ds_write_b128 v145, v[44:47] offset:0
v_mfma_f32_16x16x32_bf16 v[68:71], v[128:131], a[72:75], v[68:71]
v_mfma_f32_16x16x32_bf16 v[72:75], v[132:135], a[72:75], v[72:75]
ds_write_b128 v145, v[48:51] offset:1024
v_mfma_f32_16x16x32_bf16 v[76:79], v[136:139], a[72:75], v[76:79]
v_mfma_f32_16x16x32_bf16 v[80:83], v[140:143], a[72:75], v[80:83]
ds_write_b128 v145, v[52:55] offset:2048
s_waitcnt vmcnt(4)
v_mfma_f32_16x16x32_bf16 v[64:67], v[104:107], a[88:91], v[64:67]
v_mfma_f32_16x16x32_bf16 v[68:71], v[108:111], a[88:91], v[68:71]
ds_write_b128 v145, v[56:59] offset:3072
v_mfma_f32_16x16x32_bf16 v[72:75], v[112:115], a[88:91], v[72:75]
v_mfma_f32_16x16x32_bf16 v[76:79], v[116:119], a[88:91], v[76:79]
ds_write_b128 v145, v[60:63] offset:4096
v_mfma_f32_16x16x32_bf16 v[80:83], v[120:123], a[88:91], v[80:83]
s_waitcnt vmcnt(3)
v_mfma_f32_16x16x32_bf16 v[84:87], v[124:127], a[76:79], v[84:87]
s_nop 0
ds_write_b128 v146, v[64:67] offset:5120
v_mfma_f32_16x16x32_bf16 v[88:91], v[128:131], a[76:79], v[88:91]
v_mfma_f32_16x16x32_bf16 v[92:95], v[132:135], a[76:79], v[92:95]
ds_write_b128 v146, v[68:71] offset:6144
v_mfma_f32_16x16x32_bf16 v[96:99], v[136:139], a[76:79], v[96:99]
v_mfma_f32_16x16x32_bf16 v[100:103], v[140:143], a[76:79], v[100:103]
ds_write_b128 v146, v[72:75] offset:7168
s_waitcnt vmcnt(2)
v_mfma_f32_16x16x32_bf16 v[84:87], v[104:107], a[92:95], v[84:87]
v_mfma_f32_16x16x32_bf16 v[88:91], v[108:111], a[92:95], v[88:91]
ds_write_b128 v146, v[76:79] offset:8192
v_mfma_f32_16x16x32_bf16 v[92:95], v[112:115], a[92:95], v[92:95]
v_mfma_f32_16x16x32_bf16 v[96:99], v[116:119], a[92:95], v[96:99]
ds_write_b128 v146, v[80:83] offset:9216
v_mfma_f32_16x16x32_bf16 v[100:103], v[120:123], a[92:95], v[100:103]
s_waitcnt vmcnt(1)
v_mfma_f32_16x16x32_bf16 v[24:27], v[124:127], a[64:67], v[24:27]
s_nop 0
ds_write_b128 v147, v[84:87] offset:10240
v_mfma_f32_16x16x32_bf16 v[28:31], v[128:131], a[64:67], v[28:31]
v_mfma_f32_16x16x32_bf16 v[32:35], v[132:135], a[64:67], v[32:35]
ds_write_b128 v147, v[88:91] offset:11264
v_mfma_f32_16x16x32_bf16 v[36:39], v[136:139], a[64:67], v[36:39]
v_mfma_f32_16x16x32_bf16 v[40:43], v[140:143], a[64:67], v[40:43]
ds_write_b128 v147, v[92:95] offset:12288
s_waitcnt vmcnt(0)
v_mfma_f32_16x16x32_bf16 v[24:27], v[104:107], a[80:83], v[24:27]
v_mfma_f32_16x16x32_bf16 v[28:31], v[108:111], a[80:83], v[28:31]
ds_write_b128 v147, v[96:99] offset:13312
v_mfma_f32_16x16x32_bf16 v[32:35], v[112:115], a[80:83], v[32:35]
v_mfma_f32_16x16x32_bf16 v[36:39], v[116:119], a[80:83], v[36:39]
ds_write_b128 v147, v[100:103] offset:14336
v_mfma_f32_16x16x32_bf16 v[40:43], v[120:123], a[80:83], v[40:43]
s_waitcnt lgkmcnt(0)
s_barrier
ds_read_b128 v[44:47], v144 offset:0
ds_read_b128 v[48:51], v144 offset:5120
ds_read_b128 v[52:55], v144 offset:10240
ds_read_b128 v[56:59], v144 offset:1024
ds_read_b128 v[60:63], v144 offset:6144
ds_read_b128 v[64:67], v144 offset:11264
ds_read_b128 v[68:71], v144 offset:2048
ds_read_b128 v[72:75], v144 offset:7168
ds_read_b128 v[76:79], v144 offset:12288
ds_read_b128 v[80:83], v144 offset:3072
ds_read_b128 v[84:87], v144 offset:8192
ds_read_b128 v[88:91], v144 offset:13312
ds_read_b128 v[92:95], v144 offset:4096
ds_read_b128 v[96:99], v144 offset:9216
ds_read_b128 v[100:103], v144 offset:14336
s_mul_i32 s98, s18, 163840
s_cmp_eq_u32 s19, 0
s_cbranch_scc1 L_if41
s_mul_i32 s22, s32, 20480
s_mul_i32 s23, s21, 160
s_add_u32 s22, s22, s23
v_lshrrev_b32 v106, 2, v0
v_mul_u32_u24 v104, 1280, v106
v_add_u32 v104, s22, v104
v_and_b32 v105, 3, v0
v_lshl_add_u32 v106, v105, 4, v106
v_lshlrev_b32 v106, 2, v106
v_lshl_add_u32 v104, v105, 4, v104
v_lshlrev_b32 v105, 3, v105
v_sub_u32 v105, v104, v105
L_if41:
s_mul_i32 s99, s32, 20480
s_mul_i32 s22, s21, 2560
s_add_u32 s99, s99, s22
s_add_u32 s99, s99, s28
s_add_u32 s99, s99, 15859712
s_lshl_b32 s100, s32, 10
s_lshl_b32 s22, s21, 7
s_add_u32 s100, s100, s22
v_lshrrev_b32 v114, 1, v19
s_add_u32 s100, s100, s29
s_add_u32 s100, s100, 21364736
s_waitcnt lgkmcnt(14)
v_pk_add_f32 v[24:25], v[24:25], v[44:45]
v_pk_add_f32 v[26:27], v[26:27], v[46:47]
s_waitcnt lgkmcnt(12)
v_pk_add_f32 v[48:49], v[48:49], v[52:53]
v_pk_add_f32 v[50:51], v[50:51], v[54:55]
v_pk_add_f32 v[24:25], v[24:25], v[48:49]
v_pk_add_f32 v[26:27], v[26:27], v[50:51]
v_cvt_pk_bf16_f32 v4, v24, v25
v_cvt_pk_bf16_f32 v5, v26, v27
s_waitcnt lgkmcnt(11)
v_pk_add_f32 v[28:29], v[28:29], v[56:57]
v_pk_add_f32 v[30:31], v[30:31], v[58:59]
s_waitcnt lgkmcnt(9)
v_pk_add_f32 v[60:61], v[60:61], v[64:65]
v_pk_add_f32 v[62:63], v[62:63], v[66:67]
v_pk_add_f32 v[28:29], v[28:29], v[60:61]
v_pk_add_f32 v[30:31], v[30:31], v[62:63]
v_cvt_pk_bf16_f32 v6, v28, v29
v_cvt_pk_bf16_f32 v7, v30, v31
s_waitcnt lgkmcnt(8)
v_pk_add_f32 v[32:33], v[32:33], v[68:69]
v_pk_add_f32 v[34:35], v[34:35], v[70:71]
s_waitcnt lgkmcnt(6)
v_pk_add_f32 v[72:73], v[72:73], v[76:77]
v_pk_add_f32 v[74:75], v[74:75], v[78:79]
v_pk_add_f32 v[32:33], v[32:33], v[72:73]
v_pk_add_f32 v[34:35], v[34:35], v[74:75]
v_cvt_pk_bf16_f32 v8, v32, v33
v_cvt_pk_bf16_f32 v9, v34, v35
s_waitcnt lgkmcnt(5)
v_pk_add_f32 v[36:37], v[36:37], v[80:81]
v_pk_add_f32 v[38:39], v[38:39], v[82:83]
s_waitcnt lgkmcnt(3)
v_pk_add_f32 v[84:85], v[84:85], v[88:89]
v_pk_add_f32 v[86:87], v[86:87], v[90:91]
v_pk_add_f32 v[36:37], v[36:37], v[84:85]
v_pk_add_f32 v[38:39], v[38:39], v[86:87]
v_cvt_pk_bf16_f32 v10, v36, v37
v_cvt_pk_bf16_f32 v11, v38, v39
s_waitcnt lgkmcnt(2)
v_pk_add_f32 v[40:41], v[40:41], v[92:93]
v_pk_add_f32 v[42:43], v[42:43], v[94:95]
s_waitcnt lgkmcnt(0)
v_pk_add_f32 v[96:97], v[96:97], v[100:101]
v_pk_add_f32 v[98:99], v[98:99], v[102:103]
v_pk_add_f32 v[40:41], v[40:41], v[96:97]
v_pk_add_f32 v[42:43], v[42:43], v[98:99]
v_cvt_pk_bf16_f32 v12, v40, v41
v_cvt_pk_bf16_f32 v13, v42, v43
s_cmp_eq_u32 s19, 0
s_cbranch_scc0 L_if44
buffer_store_dwordx4 v[4:7], v1, s[4:7], s99 offen sc1
buffer_store_dwordx4 v[8:11], v1, s[4:7], s99 offen offset:1024 sc1
buffer_store_dwordx2 v[12:13], v17, s[4:7], s99 offen offset:2048 sc1
v_pk_add_f32 v[108:109], v[24:25], v[26:27]
v_pk_mul_f32 v[110:111], v[24:25], v[24:25]
v_pk_fma_f32 v[110:111], v[26:27], v[26:27], v[110:111]
v_pk_add_f32 v[108:109], v[108:109], v[28:29]
v_pk_fma_f32 v[110:111], v[28:29], v[28:29], v[110:111]
v_pk_add_f32 v[108:109], v[108:109], v[30:31]
v_pk_fma_f32 v[110:111], v[30:31], v[30:31], v[110:111]
v_pk_add_f32 v[108:109], v[108:109], v[32:33]
v_pk_fma_f32 v[110:111], v[32:33], v[32:33], v[110:111]
v_pk_add_f32 v[108:109], v[108:109], v[34:35]
v_pk_fma_f32 v[110:111], v[34:35], v[34:35], v[110:111]
v_pk_add_f32 v[108:109], v[108:109], v[36:37]
v_pk_fma_f32 v[110:111], v[36:37], v[36:37], v[110:111]
v_pk_add_f32 v[108:109], v[108:109], v[38:39]
v_pk_fma_f32 v[110:111], v[38:39], v[38:39], v[110:111]
v_pk_add_f32 v[108:109], v[108:109], v[40:41]
v_pk_fma_f32 v[110:111], v[40:41], v[40:41], v[110:111]
v_pk_add_f32 v[108:109], v[108:109], v[42:43]
v_pk_fma_f32 v[110:111], v[42:43], v[42:43], v[110:111]
v_add_f32 v112, v108, v109
v_add_f32 v113, v110, v111
v_mov_b32 v104, v112
v_mov_b32 v105, v113
s_nop 0
v_permlane32_swap_b32 v112, v104
v_permlane32_swap_b32 v113, v105
v_add_f32 v112, v112, v104
v_add_f32 v113, v113, v105
v_mov_b32 v104, v112
v_mov_b32 v105, v113
s_nop 0
v_permlane16_swap_b32 v112, v104
v_permlane16_swap_b32 v113, v105
v_add_f32 v112, v112, v104
v_add_f32 v113, v113, v105
buffer_store_dwordx2 v[112:113], v114, s[4:7], s100 offen sc1
v_lshlrev_b32 v23, 8, v0
s_lshl_b32 s22, s17, 12
s_add_u32 s22, s22, s30
v_cndmask_b32 v23, v22, v23, s[40:41]
s_waitcnt vmcnt(0)
s_barrier
s_cmp_eq_u32 s16, 0
s_cbranch_scc0 L_if42
buffer_atomic_add v21, v23, s[4:7], s22 offen offset:16 sc1
L_if42:
s_cmp_eq_u32 s16, 0
s_cbranch_scc1 L_if43
s_mul_i32 s24, s16, 20480
s_add_u32 s25, s98, s24
s_add_u32 s26, s25, 110592
s_add_u32 m0, s24, 4294946816
s_nop 0
buffer_load_dwordx4 v1, s[4:7], s26 offen offset:0 lds
buffer_load_dwordx4 v1, s[4:7], s26 offen offset:1024 lds
buffer_load_dwordx4 v1, s[4:7], s26 offen offset:2048 lds
buffer_load_dwordx4 v1, s[4:7], s26 offen offset:3072 lds
s_add_u32 s26, s25, 114688
s_add_u32 m0, s24, 4294950912
s_nop 0
buffer_load_dwordx4 v1, s[4:7], s26 offen offset:0 lds
buffer_load_dwordx4 v1, s[4:7], s26 offen offset:1024 lds
buffer_load_dwordx4 v1, s[4:7], s26 offen offset:2048 lds
buffer_load_dwordx4 v1, s[4:7], s26 offen offset:3072 lds
s_add_u32 s26, s25, 118784
s_add_u32 m0, s24, 4294955008
s_nop 0
buffer_load_dwordx4 v1, s[4:7], s26 offen offset:0 lds
buffer_load_dwordx4 v1, s[4:7], s26 offen offset:1024 lds
buffer_load_dwordx4 v1, s[4:7], s26 offen offset:2048 lds
buffer_load_dwordx4 v1, s[4:7], s26 offen offset:3072 lds
s_add_u32 s26, s25, 122880
s_add_u32 m0, s24, 4294959104
s_nop 0
buffer_load_dwordx4 v1, s[4:7], s26 offen offset:0 lds
buffer_load_dwordx4 v1, s[4:7], s26 offen offset:1024 lds
buffer_load_dwordx4 v1, s[4:7], s26 offen offset:2048 lds
buffer_load_dwordx4 v1, s[4:7], s26 offen offset:3072 lds
s_add_u32 s26, s25, 126976
s_add_u32 m0, s24, 4294963200
s_nop 0
buffer_load_dwordx4 v1, s[4:7], s26 offen offset:0 lds
buffer_load_dwordx4 v1, s[4:7], s26 offen offset:1024 lds
buffer_load_dwordx4 v1, s[4:7], s26 offen offset:2048 lds
buffer_load_dwordx4 v1, s[4:7], s26 offen offset:3072 lds
L_if43:
s_branch L_if44_e
L_if44:
ds_bpermute_b32 v116, v106, v4
ds_bpermute_b32 v117, v106, v5
ds_bpermute_b32 v118, v106, v6
ds_bpermute_b32 v119, v106, v7
ds_bpermute_b32 v120, v106, v8
ds_bpermute_b32 v121, v106, v9
ds_bpermute_b32 v122, v106, v10
ds_bpermute_b32 v123, v106, v11
ds_bpermute_b32 v124, v106, v12
ds_bpermute_b32 v125, v106, v13
s_waitcnt lgkmcnt(6)
buffer_store_dwordx4 v[116:119], v104, s[8:11], 0 offen
s_waitcnt lgkmcnt(2)
buffer_store_dwordx4 v[120:123], v104, s[8:11], 0 offen offset:64
s_waitcnt lgkmcnt(0)
buffer_store_dwordx2 v[124:125], v105, s[8:11], 0 offen offset:128
L_if44_e:
s_add_u32 s19, s19, 1
s_add_u32 s28, s28, 5242880
s_add_u32 s29, s29, 262144
s_add_u32 s30, s30, 32
s_cmp_lt_u32 s19, 2
s_cbranch_scc1 M_layer
M_end:
s_endpgm
.section .rodata,"a"
.p2align 6
.amdhsa_kernel main_kernel
  .amdhsa_next_free_vgpr 512
  .amdhsa_next_free_sgpr 102
  .amdhsa_accum_offset 256
  .amdhsa_group_segment_fixed_size 0
  .amdhsa_kernarg_size 80
  .amdhsa_user_sgpr_count 2
  .amdhsa_user_sgpr_kernarg_segment_ptr 1
  .amdhsa_system_sgpr_workgroup_id_x 1
  .amdhsa_float_denorm_mode_32 3
.end_amdhsa_kernel
```
